```python
import torch

def _softmax(x, axis=-1):
    return torch.softmax(x, dim=axis)
def _gelu(x):
    return torch.nn.functional.gelu(x, approximate="tanh")
def _silu(x):
    return torch.nn.functional.silu(x)
def _sigmoid(x):
    return torch.sigmoid(x)
def _layernorm(x, axis=-1, eps=1e-5):
    m = x.mean(dim=axis, keepdim=True)
    v = x.var(dim=axis, keepdim=True, unbiased=False)
    return (x - m) / torch.sqrt(v + eps)
def _scatter_add(tgt, idx, src, axis=0):
    return tgt.clone().index_add_(axis, idx, src)
def _segment_sum(src, seg, n):
    out = torch.zeros((n,) + src.shape[1:], dtype=src.dtype)
    return out.index_add_(0, seg, src)
def _pad(x, pw):
    flat = tuple(v for pair in reversed(pw) for v in pair)
    return torch.nn.functional.pad(x, flat)

kernel_name = 'concat_heads__ssm_conv_s4d__mha_block__prompt'

def setup_inputs():

    _w = (lambda a: (lambda t: t.to(torch.bfloat16) if t.is_floating_point() else t)(torch.as_tensor(a)))
    def _A_setup():
        Bsz, L, D, N = 1, 2048, 512, 128
        return {
            "u": _w((lambda *s: torch.randn(*s, dtype=torch.bfloat16) * 0.05)(Bsz, L, D)),
            "log_A_real": _w((lambda *s: torch.randn(*s, dtype=torch.bfloat16) * 6.4)(D, N) * 0.5),
            "A_imag": _w((lambda *s: torch.randn(*s, dtype=torch.bfloat16) * 0.1)(D, N) * 3.14),
            "C_real": _w((lambda *s: torch.randn(*s, dtype=torch.bfloat16) * 0.4)(D, N) / N ** 0.5),
            "C_imag": _w((lambda *s: torch.randn(*s, dtype=torch.bfloat16) * 0.4)(D, N) / N ** 0.5),
            "log_dt": _w((lambda *s: torch.randn(*s, dtype=torch.bfloat16) * 0.1)(D) * 0.5 - 4.0),
            "D_skip": _w((lambda *s: torch.randn(*s, dtype=torch.bfloat16) * 0.1)(D)),
        }
    _A_in = _A_setup()

    def _B_setup():
        B, S, D, H = 1, 2048, 512, 32
        return {
            "x": _w((lambda *s: torch.randn(*s, dtype=torch.bfloat16) * 0.2)(B, S, D)),
            "wqkv": _w((lambda *s: torch.randn(*s, dtype=torch.bfloat16) * 0.2)(D, 3 * D)),
            "wo": _w((lambda *s: torch.randn(*s, dtype=torch.bfloat16) * 0.05)(D, D)),
        }
    _B_in = _B_setup()

    return {
        "A_u": _A_in["u"],
        "A_log_A_real": _A_in["log_A_real"],
        "A_A_imag": _A_in["A_imag"],
        "A_C_real": _A_in["C_real"],
        "A_C_imag": _A_in["C_imag"],
        "A_log_dt": _A_in["log_dt"],
        "A_D_skip": _A_in["D_skip"],
        "B_x": _B_in["x"],
        "B_wqkv": _B_in["wqkv"],
        "B_wo": _B_in["wo"],
    }

def reference(A_u, A_log_A_real, A_A_imag, A_C_real, A_C_imag, A_log_dt, A_D_skip, B_x, B_wqkv, B_wo):
    def _A_ref(u, log_A_real, A_imag, C_real, C_imag, log_dt, D_skip):
        L = u.shape[1]
        dt = torch.exp(log_dt)
        A = -torch.exp(log_A_real) + 1j * A_imag
        C = (C_real + 1j * C_imag) * dt[:, None]
        pos = (lambda x, dt: x.to(dt))(torch.arange(L), log_dt.dtype)
        P = torch.exp((A * dt[:, None])[:, :, None] * pos[None, None, :])
        K = 2.0 * torch.einsum("dn,dnl->dl", C, P).real
        L2 = 2 * L
        u_t = (lambda x, *d: x.permute(*d))(u, 0, 2, 1)
        Kf = (lambda x, *a, **k: torch.fft.rfft(x.float(), *a, **k))(K, L2)
        Uf = (lambda x, *a, **k: torch.fft.rfft(x.float(), *a, **k))(u_t, L2)
        y = (lambda x, *a, **k: torch.fft.irfft(x, *a, **k).to(torch.bfloat16))(Uf * Kf[None, :, :], L2)[:, :, :L]
        y = (lambda x, *d: x.permute(*d))(y, 0, 2, 1)
        return y + u * D_skip[None, None, :]

    def _B_ref(x, wqkv, wo):
        B, S, D = x.shape
        H = 32
        Dh = D // H
        qkv = (lambda x, *d: x.permute(*d))((x @ wqkv).reshape(B, S, 3, H, Dh), 2, 0, 3, 1, 4)
        q, k, v = qkv[0], qkv[1], qkv[2]
        scores = torch.einsum("bhqd,bhkd->bhqk", q, k) * (Dh ** -0.5)
        p = _softmax(scores, axis=-1)
        o = torch.einsum("bhqk,bhkd->bhqd", p, v)
        return (lambda x, *d: x.permute(*d))(o, 0, 2, 1, 3).reshape(B, S, D) @ wo

    a = _A_ref(A_u, A_log_A_real, A_A_imag, A_C_real, A_C_imag, A_log_dt, A_D_skip)
    b = _B_ref(B_x, B_wqkv, B_wo)
    return torch.concatenate([a, b], axis=-1)
```

```asm
; @launch grid=(256,1,1) block=(768,1,1) lds=163840
.amdgcn_target "amdgcn-amd-amdhsa--gfx950"
.text
.globl concat_heads__ssm_conv_s4d__mha_block__prompt_kernel
.p2align 8
.type concat_heads__ssm_conv_s4d__mha_block__prompt_kernel,@function
concat_heads__ssm_conv_s4d__mha_block__prompt_kernel:
  s_cmp_ge_u32 s2, 256
  s_cbranch_scc1 concat_heads__ssm_conv_s4d__mha_block__prompt_kernel_end
  s_load_dwordx2 s[8:9], s[0:1], 96
  s_load_dwordx4 s[4:7], s[0:1], 56
  v_lshrrev_b32 v1, 6, v0
  v_and_b32 v2, 63, v0
  v_readfirstlane_b32 s68, v1
  v_lshlrev_b32 v3, 4, v2
  s_and_b32 s27, s2, 7
  s_lshr_b32 s28, s2, 3
  s_cmp_ge_u32 s68, 8
  s_cbranch_scc1 concat_heads__ssm_conv_s4d__mha_block__prompt_kernel_aux1
  s_cmp_ge_u32 s2, 192
  s_cbranch_scc1 concat_heads__ssm_conv_s4d__mha_block__prompt_kernel_ut
  s_and_b32 s24, s68, 3
  s_and_b32 s25, s27, 3
  s_lshl_b32 s25, s25, 2
  s_and_b32 s29, s28, 3
  s_add_u32 s25, s25, s29
  s_lshr_b32 s26, s27, 2
  s_mul_i32 s26, s26, 6
  s_lshr_b32 s29, s28, 2
  s_add_u32 s26, s26, s29
  s_cmp_ge_u32 s68, 4
  s_cbranch_scc0 concat_heads__ssm_conv_s4d__mha_block__prompt_kernel_comp
  v_lshrrev_b32 v4, 3, v2
  v_lshlrev_b32 v4, 10, v4
  v_and_b32 v7, 7, v2
  v_lshrrev_b32 v5, 4, v2
  v_xor_b32 v6, v7, v5
  v_lshl_add_u32 v10, v6, 4, v4
  v_xor_b32 v6, 4, v6
  v_lshl_add_u32 v11, v6, 4, v4
  v_mul_u32_u24 v4, 3072, v5
  v_bfe_u32 v7, v2, 2, 2
  v_xor_b32 v7, v7, v5
  v_lshlrev_b32 v7, 2, v7
  v_and_b32 v6, 3, v2
  v_add_u32 v7, v7, v6
  v_lshl_add_u32 v12, v7, 4, v4
  s_lshl_b32 s30, s25, 17
  s_lshl_b32 s33, s24, 15
  s_add_u32 s30, s30, s33
  s_mul_i32 s31, s24, 49152
  s_lshl_b32 s33, s26, 8
  s_add_u32 s31, s31, s33
  s_lshl_b32 s32, s24, 12
  s_and_b32 s35, s28, 3
  s_lshl_b32 s35, s35, 1
  s_lshr_b32 s36, s28, 2
  s_add_u32 s35, s35, s36
  s_add_u32 s35, s35, s27
  s_and_b32 s35, s35, 7
  s_waitcnt lgkmcnt(0)
  s_mov_b32 s16, s4
  s_mov_b32 s17, s5
  s_mov_b32 s18, 2097152
  s_mov_b32 s19, 0x20000
  s_mov_b32 s20, s6
  s_mov_b32 s21, s7
  s_mov_b32 s22, 1572864
  s_mov_b32 s23, 0x20000
  s_lshl_b32 s36, s35, 7
  s_add_u32 s36, s36, s30
  s_mul_i32 s37, s35, 196608
  s_add_u32 s37, s37, s31
  s_add_u32 m0, s32, 0
  s_add_u32 s34, s36, 0
  buffer_load_dwordx4 v10, s[16:19], s34 offen lds
  s_add_u32 m0, s32, 16384
  s_add_u32 s34, s37, 0
  buffer_load_dwordx4 v12, s[20:23], s34 offen lds
  s_add_u32 m0, s32, 1024
  s_add_u32 s34, s36, 8192
  buffer_load_dwordx4 v11, s[16:19], s34 offen lds
  s_add_u32 m0, s32, 17408
  s_add_u32 s34, s37, 12288
  buffer_load_dwordx4 v12, s[20:23], s34 offen lds
  s_add_u32 m0, s32, 2048
  s_add_u32 s34, s36, 16384
  buffer_load_dwordx4 v10, s[16:19], s34 offen lds
  s_add_u32 m0, s32, 18432
  s_add_u32 s34, s37, 24576
  buffer_load_dwordx4 v12, s[20:23], s34 offen lds
  s_add_u32 m0, s32, 3072
  s_add_u32 s34, s36, 24576
  buffer_load_dwordx4 v11, s[16:19], s34 offen lds
  s_add_u32 m0, s32, 19456
  s_add_u32 s34, s37, 36864
  buffer_load_dwordx4 v12, s[20:23], s34 offen lds
  s_add_u32 s35, s35, 1
  s_and_b32 s35, s35, 7
  s_lshl_b32 s36, s35, 7
  s_add_u32 s36, s36, s30
  s_mul_i32 s37, s35, 196608
  s_add_u32 s37, s37, s31
  s_add_u32 m0, s32, 32768
  s_add_u32 s34, s36, 0
  buffer_load_dwordx4 v10, s[16:19], s34 offen lds
  s_add_u32 m0, s32, 49152
  s_add_u32 s34, s37, 0
  buffer_load_dwordx4 v12, s[20:23], s34 offen lds
  s_add_u32 m0, s32, 33792
  s_add_u32 s34, s36, 8192
  buffer_load_dwordx4 v11, s[16:19], s34 offen lds
  s_add_u32 m0, s32, 50176
  s_add_u32 s34, s37, 12288
  buffer_load_dwordx4 v12, s[20:23], s34 offen lds
  s_add_u32 m0, s32, 34816
  s_add_u32 s34, s36, 16384
  buffer_load_dwordx4 v10, s[16:19], s34 offen lds
  s_add_u32 m0, s32, 51200
  s_add_u32 s34, s37, 24576
  buffer_load_dwordx4 v12, s[20:23], s34 offen lds
  s_add_u32 m0, s32, 35840
  s_add_u32 s34, s36, 24576
  buffer_load_dwordx4 v11, s[16:19], s34 offen lds
  s_add_u32 m0, s32, 52224
  s_add_u32 s34, s37, 36864
  buffer_load_dwordx4 v12, s[20:23], s34 offen lds
  s_add_u32 s35, s35, 1
  s_and_b32 s35, s35, 7
  s_waitcnt vmcnt(8)
  s_barrier
  s_lshl_b32 s36, s35, 7
  s_add_u32 s36, s36, s30
  s_mul_i32 s37, s35, 196608
  s_add_u32 s37, s37, s31
  s_add_u32 m0, s32, 65536
  s_add_u32 s34, s36, 0
  buffer_load_dwordx4 v10, s[16:19], s34 offen lds
  s_add_u32 m0, s32, 81920
  s_add_u32 s34, s37, 0
  buffer_load_dwordx4 v12, s[20:23], s34 offen lds
  s_add_u32 m0, s32, 66560
  s_add_u32 s34, s36, 8192
  buffer_load_dwordx4 v11, s[16:19], s34 offen lds
  s_add_u32 m0, s32, 82944
  s_add_u32 s34, s37, 12288
  buffer_load_dwordx4 v12, s[20:23], s34 offen lds
  s_add_u32 m0, s32, 67584
  s_add_u32 s34, s36, 16384
  buffer_load_dwordx4 v10, s[16:19], s34 offen lds
  s_add_u32 m0, s32, 83968
  s_add_u32 s34, s37, 24576
  buffer_load_dwordx4 v12, s[20:23], s34 offen lds
  s_add_u32 m0, s32, 68608
  s_add_u32 s34, s36, 24576
  buffer_load_dwordx4 v11, s[16:19], s34 offen lds
  s_add_u32 m0, s32, 84992
  s_add_u32 s34, s37, 36864
  buffer_load_dwordx4 v12, s[20:23], s34 offen lds
  s_add_u32 s35, s35, 1
  s_and_b32 s35, s35, 7
  s_lshl_b32 s36, s35, 7
  s_add_u32 s36, s36, s30
  s_mul_i32 s37, s35, 196608
  s_add_u32 s37, s37, s31
  s_add_u32 m0, s32, 98304
  s_add_u32 s34, s36, 0
  buffer_load_dwordx4 v10, s[16:19], s34 offen lds
  s_add_u32 m0, s32, 114688
  s_add_u32 s34, s37, 0
  buffer_load_dwordx4 v12, s[20:23], s34 offen lds
  s_add_u32 m0, s32, 99328
  s_add_u32 s34, s36, 8192
  buffer_load_dwordx4 v11, s[16:19], s34 offen lds
  s_add_u32 m0, s32, 115712
  s_add_u32 s34, s37, 12288
  buffer_load_dwordx4 v12, s[20:23], s34 offen lds
  s_add_u32 m0, s32, 100352
  s_add_u32 s34, s36, 16384
  buffer_load_dwordx4 v10, s[16:19], s34 offen lds
  s_add_u32 m0, s32, 116736
  s_add_u32 s34, s37, 24576
  buffer_load_dwordx4 v12, s[20:23], s34 offen lds
  s_add_u32 m0, s32, 101376
  s_add_u32 s34, s36, 24576
  buffer_load_dwordx4 v11, s[16:19], s34 offen lds
  s_add_u32 m0, s32, 117760
  s_add_u32 s34, s37, 36864
  buffer_load_dwordx4 v12, s[20:23], s34 offen lds
  s_add_u32 s35, s35, 1
  s_and_b32 s35, s35, 7
  s_waitcnt vmcnt(16)
  s_barrier
  s_lshl_b32 s36, s35, 7
  s_add_u32 s36, s36, s30
  s_mul_i32 s37, s35, 196608
  s_add_u32 s37, s37, s31
  s_add_u32 m0, s32, 0
  s_add_u32 s34, s36, 0
  buffer_load_dwordx4 v10, s[16:19], s34 offen lds
  s_add_u32 m0, s32, 16384
  s_add_u32 s34, s37, 0
  buffer_load_dwordx4 v12, s[20:23], s34 offen lds
  s_add_u32 m0, s32, 1024
  s_add_u32 s34, s36, 8192
  buffer_load_dwordx4 v11, s[16:19], s34 offen lds
  s_add_u32 m0, s32, 17408
  s_add_u32 s34, s37, 12288
  buffer_load_dwordx4 v12, s[20:23], s34 offen lds
  s_add_u32 m0, s32, 2048
  s_add_u32 s34, s36, 16384
  buffer_load_dwordx4 v10, s[16:19], s34 offen lds
  s_add_u32 m0, s32, 18432
  s_add_u32 s34, s37, 24576
  buffer_load_dwordx4 v12, s[20:23], s34 offen lds
  s_add_u32 m0, s32, 3072
  s_add_u32 s34, s36, 24576
  buffer_load_dwordx4 v11, s[16:19], s34 offen lds
  s_add_u32 m0, s32, 19456
  s_add_u32 s34, s37, 36864
  buffer_load_dwordx4 v12, s[20:23], s34 offen lds
  s_add_u32 s35, s35, 1
  s_and_b32 s35, s35, 7
  s_waitcnt vmcnt(16)
  s_barrier
  s_lshl_b32 s36, s35, 7
  s_add_u32 s36, s36, s30
  s_mul_i32 s37, s35, 196608
  s_add_u32 s37, s37, s31
  s_add_u32 m0, s32, 32768
  s_add_u32 s34, s36, 0
  buffer_load_dwordx4 v10, s[16:19], s34 offen lds
  s_add_u32 m0, s32, 49152
  s_add_u32 s34, s37, 0
  buffer_load_dwordx4 v12, s[20:23], s34 offen lds
  s_add_u32 m0, s32, 33792
  s_add_u32 s34, s36, 8192
  buffer_load_dwordx4 v11, s[16:19], s34 offen lds
  s_add_u32 m0, s32, 50176
  s_add_u32 s34, s37, 12288
  buffer_load_dwordx4 v12, s[20:23], s34 offen lds
  s_add_u32 m0, s32, 34816
  s_add_u32 s34, s36, 16384
  buffer_load_dwordx4 v10, s[16:19], s34 offen lds
  s_add_u32 m0, s32, 51200
  s_add_u32 s34, s37, 24576
  buffer_load_dwordx4 v12, s[20:23], s34 offen lds
  s_add_u32 m0, s32, 35840
  s_add_u32 s34, s36, 24576
  buffer_load_dwordx4 v11, s[16:19], s34 offen lds
  s_add_u32 m0, s32, 52224
  s_add_u32 s34, s37, 36864
  buffer_load_dwordx4 v12, s[20:23], s34 offen lds
  s_add_u32 s35, s35, 1
  s_and_b32 s35, s35, 7
  s_waitcnt vmcnt(16)
  s_barrier
  s_lshl_b32 s36, s35, 7
  s_add_u32 s36, s36, s30
  s_mul_i32 s37, s35, 196608
  s_add_u32 s37, s37, s31
  s_add_u32 m0, s32, 65536
  s_add_u32 s34, s36, 0
  buffer_load_dwordx4 v10, s[16:19], s34 offen lds
  s_add_u32 m0, s32, 81920
  s_add_u32 s34, s37, 0
  buffer_load_dwordx4 v12, s[20:23], s34 offen lds
  s_add_u32 m0, s32, 66560
  s_add_u32 s34, s36, 8192
  buffer_load_dwordx4 v11, s[16:19], s34 offen lds
  s_add_u32 m0, s32, 82944
  s_add_u32 s34, s37, 12288
  buffer_load_dwordx4 v12, s[20:23], s34 offen lds
  s_add_u32 m0, s32, 67584
  s_add_u32 s34, s36, 16384
  buffer_load_dwordx4 v10, s[16:19], s34 offen lds
  s_add_u32 m0, s32, 83968
  s_add_u32 s34, s37, 24576
  buffer_load_dwordx4 v12, s[20:23], s34 offen lds
  s_add_u32 m0, s32, 68608
  s_add_u32 s34, s36, 24576
  buffer_load_dwordx4 v11, s[16:19], s34 offen lds
  s_add_u32 m0, s32, 84992
  s_add_u32 s34, s37, 36864
  buffer_load_dwordx4 v12, s[20:23], s34 offen lds
  s_add_u32 s35, s35, 1
  s_and_b32 s35, s35, 7
  s_waitcnt vmcnt(16)
  s_barrier
  s_lshl_b32 s36, s35, 7
  s_add_u32 s36, s36, s30
  s_mul_i32 s37, s35, 196608
  s_add_u32 s37, s37, s31
  s_add_u32 m0, s32, 98304
  s_add_u32 s34, s36, 0
  buffer_load_dwordx4 v10, s[16:19], s34 offen lds
  s_add_u32 m0, s32, 114688
  s_add_u32 s34, s37, 0
  buffer_load_dwordx4 v12, s[20:23], s34 offen lds
  s_add_u32 m0, s32, 99328
  s_add_u32 s34, s36, 8192
  buffer_load_dwordx4 v11, s[16:19], s34 offen lds
  s_add_u32 m0, s32, 115712
  s_add_u32 s34, s37, 12288
  buffer_load_dwordx4 v12, s[20:23], s34 offen lds
  s_add_u32 m0, s32, 100352
  s_add_u32 s34, s36, 16384
  buffer_load_dwordx4 v10, s[16:19], s34 offen lds
  s_add_u32 m0, s32, 116736
  s_add_u32 s34, s37, 24576
  buffer_load_dwordx4 v12, s[20:23], s34 offen lds
  s_add_u32 m0, s32, 101376
  s_add_u32 s34, s36, 24576
  buffer_load_dwordx4 v11, s[16:19], s34 offen lds
  s_add_u32 m0, s32, 117760
  s_add_u32 s34, s37, 36864
  buffer_load_dwordx4 v12, s[20:23], s34 offen lds
  s_add_u32 s35, s35, 1
  s_and_b32 s35, s35, 7
  s_waitcnt vmcnt(16)
  s_barrier
  s_waitcnt vmcnt(8)
  s_barrier
  s_waitcnt vmcnt(0)
  s_barrier
  s_load_dwordx8 s[40:47], s[0:1], 8
  s_load_dwordx2 s[48:49], s[0:1], 40
  s_lshr_b32 s50, s68, 2
  s_lshl_b32 s51, s2, 1
  s_add_u32 s50, s50, s51
  s_lshl_b32 s51, s50, 8
  s_bfe_u32 s71, s68, 0x10001
  s_lshl_b32 s71, s71, 7
  s_add_u32 s51, s51, s71
  v_lshlrev_b32 v4, 1, v2
  v_add_u32 v4, s51, v4
  s_lshr_b32 s50, s50, 1
  s_lshl_b32 s50, s50, 2
  s_waitcnt lgkmcnt(0)
  global_load_ushort v160, v4, s[40:41]
  global_load_ushort v161, v4, s[42:43]
  global_load_ushort v162, v4, s[44:45]
  global_load_ushort v163, v4, s[46:47]
  s_load_dword s70, s[48:49], s50
  s_branch concat_heads__ssm_conv_s4d__mha_block__prompt_kernel_s1
concat_heads__ssm_conv_s4d__mha_block__prompt_kernel_comp:
  s_load_dwordx8 s[40:47], s[0:1], 8
  s_load_dwordx2 s[48:49], s[0:1], 40
  s_lshr_b32 s50, s68, 2
  s_lshl_b32 s51, s2, 1
  s_add_u32 s50, s50, s51
  s_lshl_b32 s51, s50, 8
  s_bfe_u32 s71, s68, 0x10001
  s_lshl_b32 s71, s71, 7
  s_add_u32 s51, s51, s71
  v_lshlrev_b32 v4, 1, v2
  v_add_u32 v4, s51, v4
  s_lshr_b32 s50, s50, 1
  s_lshl_b32 s50, s50, 2
  s_waitcnt lgkmcnt(0)
  global_load_ushort v160, v4, s[40:41]
  global_load_ushort v161, v4, s[42:43]
  global_load_ushort v162, v4, s[44:45]
  global_load_ushort v163, v4, s[46:47]
  s_load_dword s70, s[48:49], s50
  s_lshr_b32 s35, s24, 1
  s_and_b32 s36, s24, 1
  v_and_b32 v4, 31, v2
  v_lshrrev_b32 v8, 5, v2
  v_bfe_u32 v5, v2, 1, 3
  v_xor_b32 v5, v5, v8
  v_lshlrev_b32 v5, 4, v5
  v_lshl_add_u32 v5, v4, 7, v5
  s_lshl_b32 s37, s35, 13
  v_add_u32 v5, s37, v5
  v_xor_b32 v16, 0, v5
  v_xor_b32 v17, 32, v5
  v_xor_b32 v18, 64, v5
  v_xor_b32 v19, 96, v5
  v_bfe_u32 v4, v2, 2, 2
  v_lshl_add_u32 v6, v8, 3, v4
  v_lshlrev_b32 v6, 8, v6
  v_bfe_u32 v7, v2, 4, 1
  v_lshl_add_u32 v6, v7, 5, v6
  v_and_b32 v7, 3, v2
  v_lshl_add_u32 v6, v7, 3, v6
  s_lshl_b32 s37, s36, 1
  s_add_u32 s38, s37, 0
  v_xor_b32 v7, s38, v4
  v_lshl_add_u32 v7, v7, 6, v6
  v_add_u32 v20, 0x4000, v7
  s_add_u32 s38, s37, 1
  v_xor_b32 v7, s38, v4
  v_lshl_add_u32 v7, v7, 6, v6
  v_add_u32 v21, 0x4000, v7
  v_mov_b32 v96, 0
  v_mov_b32 v97, 0
  v_mov_b32 v98, 0
  v_mov_b32 v99, 0
  v_mov_b32 v100, 0
  v_mov_b32 v101, 0
  v_mov_b32 v102, 0
  v_mov_b32 v103, 0
  v_mov_b32 v104, 0
  v_mov_b32 v105, 0
  v_mov_b32 v106, 0
  v_mov_b32 v107, 0
  v_mov_b32 v108, 0
  v_mov_b32 v109, 0
  v_mov_b32 v110, 0
  v_mov_b32 v111, 0
  v_mov_b32 v112, 0
  v_mov_b32 v113, 0
  v_mov_b32 v114, 0
  v_mov_b32 v115, 0
  v_mov_b32 v116, 0
  v_mov_b32 v117, 0
  v_mov_b32 v118, 0
  v_mov_b32 v119, 0
  v_mov_b32 v120, 0
  v_mov_b32 v121, 0
  v_mov_b32 v122, 0
  v_mov_b32 v123, 0
  v_mov_b32 v124, 0
  v_mov_b32 v125, 0
  v_mov_b32 v126, 0
  v_mov_b32 v127, 0
  v_mov_b32 v128, 0
  v_mov_b32 v129, 0
  v_mov_b32 v130, 0
  v_mov_b32 v131, 0
  v_mov_b32 v132, 0
  v_mov_b32 v133, 0
  v_mov_b32 v134, 0
  v_mov_b32 v135, 0
  v_mov_b32 v136, 0
  v_mov_b32 v137, 0
  v_mov_b32 v138, 0
  v_mov_b32 v139, 0
  v_mov_b32 v140, 0
  v_mov_b32 v141, 0
  v_mov_b32 v142, 0
  v_mov_b32 v143, 0
  v_mov_b32 v144, 0
  v_mov_b32 v145, 0
  v_mov_b32 v146, 0
  v_mov_b32 v147, 0
  v_mov_b32 v148, 0
  v_mov_b32 v149, 0
  v_mov_b32 v150, 0
  v_mov_b32 v151, 0
  v_mov_b32 v152, 0
  v_mov_b32 v153, 0
  v_mov_b32 v154, 0
  v_mov_b32 v155, 0
  v_mov_b32 v156, 0
  v_mov_b32 v157, 0
  v_mov_b32 v158, 0
  v_mov_b32 v159, 0
  s_mov_b32 s45, 0
  s_mov_b32 s47, 4294868992
  s_mov_b32 s48, 32768
  s_cmp_ge_u32 s26, 8
  s_cbranch_scc1 concat_heads__ssm_conv_s4d__mha_block__prompt_kernel_vtype
  s_barrier
  ds_read_b128 v[32:35], v16 offset:0
  ds_read_b128 v[36:39], v16 offset:4096
  ds_read_b64_tr_b16 v[64:65], v20 offset:0
  ds_read_b64_tr_b16 v[66:67], v20 offset:1024
  ds_read_b64_tr_b16 v[68:69], v21 offset:0
  ds_read_b64_tr_b16 v[70:71], v21 offset:1024
  ds_read_b128 v[40:43], v17 offset:0
  ds_read_b128 v[44:47], v17 offset:4096
  ds_read_b64_tr_b16 v[72:73], v20 offset:4096
  ds_read_b64_tr_b16 v[74:75], v20 offset:5120
  ds_read_b64_tr_b16 v[76:77], v21 offset:4096
  ds_read_b64_tr_b16 v[78:79], v21 offset:5120
  s_waitcnt lgkmcnt(0)
  v_mfma_f32_32x32x16_bf16 v[96:111], v[64:67], v[32:35], v[96:111]
  ds_read_b128 v[48:51], v18 offset:0
  ds_read_b128 v[52:55], v18 offset:4096
  ds_read_b64_tr_b16 v[80:81], v20 offset:8192
  v_mfma_f32_32x32x16_bf16 v[112:127], v[68:71], v[32:35], v[112:127]
  ds_read_b64_tr_b16 v[82:83], v20 offset:9216
  ds_read_b64_tr_b16 v[84:85], v21 offset:8192
  ds_read_b64_tr_b16 v[86:87], v21 offset:9216
  v_mfma_f32_32x32x16_bf16 v[128:143], v[64:67], v[36:39], v[128:143]
  ds_read_b128 v[56:59], v19 offset:0
  ds_read_b128 v[60:63], v19 offset:4096
  ds_read_b64_tr_b16 v[88:89], v20 offset:12288
  v_mfma_f32_32x32x16_bf16 v[144:159], v[68:71], v[36:39], v[144:159]
  ds_read_b64_tr_b16 v[90:91], v20 offset:13312
  ds_read_b64_tr_b16 v[92:93], v21 offset:12288
  ds_read_b64_tr_b16 v[94:95], v21 offset:13312
  v_mfma_f32_32x32x16_bf16 v[96:111], v[72:75], v[40:43], v[96:111]
  v_mfma_f32_32x32x16_bf16 v[112:127], v[76:79], v[40:43], v[112:127]
  v_mfma_f32_32x32x16_bf16 v[128:143], v[72:75], v[44:47], v[128:143]
  v_mfma_f32_32x32x16_bf16 v[144:159], v[76:79], v[44:47], v[144:159]
  s_add_u32 s45, s45, 1
  s_cmp_eq_u32 s45, 4
  s_cselect_b32 s46, s47, s48
  s_cselect_b32 s45, 0, s45
  v_add_u32 v16, s46, v16
  v_add_u32 v17, s46, v17
  v_add_u32 v18, s46, v18
  v_add_u32 v19, s46, v19
  v_add_u32 v20, s46, v20
  v_add_u32 v21, s46, v21
  s_waitcnt lgkmcnt(0)
  s_mov_b32 s49, 1
concat_heads__ssm_conv_s4d__mha_block__prompt_kernel_gl0:
  s_barrier
  v_mfma_f32_32x32x16_bf16 v[96:111], v[80:83], v[48:51], v[96:111]
  ds_read_b128 v[32:35], v16 offset:0
  ds_read_b128 v[36:39], v16 offset:4096
  ds_read_b64_tr_b16 v[64:65], v20 offset:0
  v_mfma_f32_32x32x16_bf16 v[112:127], v[84:87], v[48:51], v[112:127]
  ds_read_b64_tr_b16 v[66:67], v20 offset:1024
  ds_read_b64_tr_b16 v[68:69], v21 offset:0
  ds_read_b64_tr_b16 v[70:71], v21 offset:1024
  v_mfma_f32_32x32x16_bf16 v[128:143], v[80:83], v[52:55], v[128:143]
  ds_read_b128 v[40:43], v17 offset:0
  ds_read_b128 v[44:47], v17 offset:4096
  ds_read_b64_tr_b16 v[72:73], v20 offset:4096
  v_mfma_f32_32x32x16_bf16 v[144:159], v[84:87], v[52:55], v[144:159]
  ds_read_b64_tr_b16 v[74:75], v20 offset:5120
  ds_read_b64_tr_b16 v[76:77], v21 offset:4096
  ds_read_b64_tr_b16 v[78:79], v21 offset:5120
  v_mfma_f32_32x32x16_bf16 v[96:111], v[88:91], v[56:59], v[96:111]
  v_mfma_f32_32x32x16_bf16 v[112:127], v[92:95], v[56:59], v[112:127]
  v_mfma_f32_32x32x16_bf16 v[128:143], v[88:91], v[60:63], v[128:143]
  v_mfma_f32_32x32x16_bf16 v[144:159], v[92:95], v[60:63], v[144:159]
  s_waitcnt lgkmcnt(0)
  v_mfma_f32_32x32x16_bf16 v[96:111], v[64:67], v[32:35], v[96:111]
  ds_read_b128 v[48:51], v18 offset:0
  ds_read_b128 v[52:55], v18 offset:4096
  ds_read_b64_tr_b16 v[80:81], v20 offset:8192
  v_mfma_f32_32x32x16_bf16 v[112:127], v[68:71], v[32:35], v[112:127]
  ds_read_b64_tr_b16 v[82:83], v20 offset:9216
  ds_read_b64_tr_b16 v[84:85], v21 offset:8192
  ds_read_b64_tr_b16 v[86:87], v21 offset:9216
  v_mfma_f32_32x32x16_bf16 v[128:143], v[64:67], v[36:39], v[128:143]
  ds_read_b128 v[56:59], v19 offset:0
  ds_read_b128 v[60:63], v19 offset:4096
  ds_read_b64_tr_b16 v[88:89], v20 offset:12288
  v_mfma_f32_32x32x16_bf16 v[144:159], v[68:71], v[36:39], v[144:159]
  ds_read_b64_tr_b16 v[90:91], v20 offset:13312
  ds_read_b64_tr_b16 v[92:93], v21 offset:12288
  ds_read_b64_tr_b16 v[94:95], v21 offset:13312
  v_mfma_f32_32x32x16_bf16 v[96:111], v[72:75], v[40:43], v[96:111]
  v_mfma_f32_32x32x16_bf16 v[112:127], v[76:79], v[40:43], v[112:127]
  v_mfma_f32_32x32x16_bf16 v[128:143], v[72:75], v[44:47], v[128:143]
  v_mfma_f32_32x32x16_bf16 v[144:159], v[76:79], v[44:47], v[144:159]
  s_add_u32 s45, s45, 1
  s_cmp_eq_u32 s45, 4
  s_cselect_b32 s46, s47, s48
  s_cselect_b32 s45, 0, s45
  v_add_u32 v16, s46, v16
  v_add_u32 v17, s46, v17
  v_add_u32 v18, s46, v18
  v_add_u32 v19, s46, v19
  v_add_u32 v20, s46, v20
  v_add_u32 v21, s46, v21
  s_add_u32 s49, s49, 1
  s_cmp_lt_u32 s49, 8
  s_waitcnt lgkmcnt(0)
  s_cbranch_scc1 concat_heads__ssm_conv_s4d__mha_block__prompt_kernel_gl0
  v_mfma_f32_32x32x16_bf16 v[96:111], v[80:83], v[48:51], v[96:111]
  v_mfma_f32_32x32x16_bf16 v[112:127], v[84:87], v[48:51], v[112:127]
  v_mfma_f32_32x32x16_bf16 v[128:143], v[80:83], v[52:55], v[128:143]
  v_mfma_f32_32x32x16_bf16 v[144:159], v[84:87], v[52:55], v[144:159]
  v_mfma_f32_32x32x16_bf16 v[96:111], v[88:91], v[56:59], v[96:111]
  v_mfma_f32_32x32x16_bf16 v[112:127], v[92:95], v[56:59], v[112:127]
  v_mfma_f32_32x32x16_bf16 v[128:143], v[88:91], v[60:63], v[128:143]
  v_mfma_f32_32x32x16_bf16 v[144:159], v[92:95], v[60:63], v[144:159]
  s_and_b32 s40, s26, 3
  s_lshl_b32 s40, s40, 3
  s_lshl_b32 s41, s36, 2
  s_add_u32 s40, s40, s41
  s_lshl_b32 s40, s40, 16
  s_lshl_b32 s41, s25, 12
  s_add_u32 s40, s40, s41
  s_lshl_b32 s41, s35, 11
  s_add_u32 s40, s40, s41
  s_mov_b32 s12, s8
  s_mov_b32 s13, s9
  s_mov_b32 s14, 33554432
  s_mov_b32 s15, 0x20000
  s_lshr_b32 s41, s26, 2
  s_mul_i32 s42, s41, 2097152
  s_add_u32 s40, s40, s42
  s_mov_b32 s43, 0x3eb8aa3b
  s_cmp_eq_u32 s41, 0
  s_cselect_b32 s43, s43, 1.0
  v_and_b32 v6, 31, v2
  v_lshlrev_b32 v6, 4, v6
  v_lshl_add_u32 v6, v8, 3, v6
  v_mov_b32 v4, s43
  v_mov_b32 v5, s43
  v_pk_mul_f32 v[96:97], v[96:97], v[4:5]
  v_pk_mul_f32 v[98:99], v[98:99], v[4:5]
  v_pk_mul_f32 v[100:101], v[100:101], v[4:5]
  v_pk_mul_f32 v[102:103], v[102:103], v[4:5]
  v_pk_mul_f32 v[104:105], v[104:105], v[4:5]
  v_pk_mul_f32 v[106:107], v[106:107], v[4:5]
  v_pk_mul_f32 v[108:109], v[108:109], v[4:5]
  v_pk_mul_f32 v[110:111], v[110:111], v[4:5]
  v_cvt_pk_bf16_f32 v32, v96, v97
  v_cvt_pk_bf16_f32 v33, v98, v99
  v_cvt_pk_bf16_f32 v34, v100, v101
  v_cvt_pk_bf16_f32 v35, v102, v103
  v_cvt_pk_bf16_f32 v36, v104, v105
  v_cvt_pk_bf16_f32 v37, v106, v107
  v_cvt_pk_bf16_f32 v38, v108, v109
  v_cvt_pk_bf16_f32 v39, v110, v111
  s_nop 0
  v_permlane32_swap_b32 v32, v34
  v_permlane32_swap_b32 v33, v35
  v_permlane32_swap_b32 v36, v38
  v_permlane32_swap_b32 v37, v39
  s_add_u32 s44, s40, 0
  buffer_store_dwordx4 v[32:35], v3, s[12:15], s44 offen sc0 sc1
  s_add_u32 s44, s40, 65536
  buffer_store_dwordx4 v[36:39], v3, s[12:15], s44 offen sc0 sc1
  v_pk_mul_f32 v[112:113], v[112:113], v[4:5]
  v_pk_mul_f32 v[114:115], v[114:115], v[4:5]
  v_pk_mul_f32 v[116:117], v[116:117], v[4:5]
  v_pk_mul_f32 v[118:119], v[118:119], v[4:5]
  v_pk_mul_f32 v[120:121], v[120:121], v[4:5]
  v_pk_mul_f32 v[122:123], v[122:123], v[4:5]
  v_pk_mul_f32 v[124:125], v[124:125], v[4:5]
  v_pk_mul_f32 v[126:127], v[126:127], v[4:5]
  v_cvt_pk_bf16_f32 v40, v112, v113
  v_cvt_pk_bf16_f32 v41, v114, v115
  v_cvt_pk_bf16_f32 v42, v116, v117
  v_cvt_pk_bf16_f32 v43, v118, v119
  v_cvt_pk_bf16_f32 v44, v120, v121
  v_cvt_pk_bf16_f32 v45, v122, v123
  v_cvt_pk_bf16_f32 v46, v124, v125
  v_cvt_pk_bf16_f32 v47, v126, v127
  s_nop 0
  v_permlane32_swap_b32 v40, v42
  v_permlane32_swap_b32 v41, v43
  v_permlane32_swap_b32 v44, v46
  v_permlane32_swap_b32 v45, v47
  s_add_u32 s44, s40, 131072
  buffer_store_dwordx4 v[40:43], v3, s[12:15], s44 offen sc0 sc1
  s_add_u32 s44, s40, 196608
  buffer_store_dwordx4 v[44:47], v3, s[12:15], s44 offen sc0 sc1
  v_pk_mul_f32 v[128:129], v[128:129], v[4:5]
  v_pk_mul_f32 v[130:131], v[130:131], v[4:5]
  v_pk_mul_f32 v[132:133], v[132:133], v[4:5]
  v_pk_mul_f32 v[134:135], v[134:135], v[4:5]
  v_pk_mul_f32 v[136:137], v[136:137], v[4:5]
  v_pk_mul_f32 v[138:139], v[138:139], v[4:5]
  v_pk_mul_f32 v[140:141], v[140:141], v[4:5]
  v_pk_mul_f32 v[142:143], v[142:143], v[4:5]
  v_cvt_pk_bf16_f32 v48, v128, v129
  v_cvt_pk_bf16_f32 v49, v130, v131
  v_cvt_pk_bf16_f32 v50, v132, v133
  v_cvt_pk_bf16_f32 v51, v134, v135
  v_cvt_pk_bf16_f32 v52, v136, v137
  v_cvt_pk_bf16_f32 v53, v138, v139
  v_cvt_pk_bf16_f32 v54, v140, v141
  v_cvt_pk_bf16_f32 v55, v142, v143
  s_nop 0
  v_permlane32_swap_b32 v48, v50
  v_permlane32_swap_b32 v49, v51
  v_permlane32_swap_b32 v52, v54
  v_permlane32_swap_b32 v53, v55
  s_add_u32 s44, s40, 1024
  buffer_store_dwordx4 v[48:51], v3, s[12:15], s44 offen sc0 sc1
  s_add_u32 s44, s40, 66560
  buffer_store_dwordx4 v[52:55], v3, s[12:15], s44 offen sc0 sc1
  v_pk_mul_f32 v[144:145], v[144:145], v[4:5]
  v_pk_mul_f32 v[146:147], v[146:147], v[4:5]
  v_pk_mul_f32 v[148:149], v[148:149], v[4:5]
  v_pk_mul_f32 v[150:151], v[150:151], v[4:5]
  v_pk_mul_f32 v[152:153], v[152:153], v[4:5]
  v_pk_mul_f32 v[154:155], v[154:155], v[4:5]
  v_pk_mul_f32 v[156:157], v[156:157], v[4:5]
  v_pk_mul_f32 v[158:159], v[158:159], v[4:5]
  v_cvt_pk_bf16_f32 v56, v144, v145
  v_cvt_pk_bf16_f32 v57, v146, v147
  v_cvt_pk_bf16_f32 v58, v148, v149
  v_cvt_pk_bf16_f32 v59, v150, v151
  v_cvt_pk_bf16_f32 v60, v152, v153
  v_cvt_pk_bf16_f32 v61, v154, v155
  v_cvt_pk_bf16_f32 v62, v156, v157
  v_cvt_pk_bf16_f32 v63, v158, v159
  s_nop 0
  v_permlane32_swap_b32 v56, v58
  v_permlane32_swap_b32 v57, v59
  v_permlane32_swap_b32 v60, v62
  v_permlane32_swap_b32 v61, v63
  s_add_u32 s44, s40, 132096
  buffer_store_dwordx4 v[56:59], v3, s[12:15], s44 offen sc0 sc1
  s_add_u32 s44, s40, 197632
  buffer_store_dwordx4 v[60:63], v3, s[12:15], s44 offen sc0 sc1
  s_branch concat_heads__ssm_conv_s4d__mha_block__prompt_kernel_s1
concat_heads__ssm_conv_s4d__mha_block__prompt_kernel_vtype:
  s_barrier
  ds_read_b128 v[32:35], v16 offset:0
  ds_read_b128 v[36:39], v16 offset:4096
  ds_read_b64_tr_b16 v[64:65], v20 offset:0
  ds_read_b64_tr_b16 v[66:67], v20 offset:1024
  ds_read_b64_tr_b16 v[68:69], v21 offset:0
  ds_read_b64_tr_b16 v[70:71], v21 offset:1024
  ds_read_b128 v[40:43], v17 offset:0
  ds_read_b128 v[44:47], v17 offset:4096
  ds_read_b64_tr_b16 v[72:73], v20 offset:4096
  ds_read_b64_tr_b16 v[74:75], v20 offset:5120
  ds_read_b64_tr_b16 v[76:77], v21 offset:4096
  ds_read_b64_tr_b16 v[78:79], v21 offset:5120
  s_waitcnt lgkmcnt(0)
  v_mfma_f32_32x32x16_bf16 v[96:111], v[32:35], v[64:67], v[96:111]
  ds_read_b128 v[48:51], v18 offset:0
  ds_read_b128 v[52:55], v18 offset:4096
  ds_read_b64_tr_b16 v[80:81], v20 offset:8192
  v_mfma_f32_32x32x16_bf16 v[112:127], v[32:35], v[68:71], v[112:127]
  ds_read_b64_tr_b16 v[82:83], v20 offset:9216
  ds_read_b64_tr_b16 v[84:85], v21 offset:8192
  ds_read_b64_tr_b16 v[86:87], v21 offset:9216
  v_mfma_f32_32x32x16_bf16 v[128:143], v[36:39], v[64:67], v[128:143]
  ds_read_b128 v[56:59], v19 offset:0
  ds_read_b128 v[60:63], v19 offset:4096
  ds_read_b64_tr_b16 v[88:89], v20 offset:12288
  v_mfma_f32_32x32x16_bf16 v[144:159], v[36:39], v[68:71], v[144:159]
  ds_read_b64_tr_b16 v[90:91], v20 offset:13312
  ds_read_b64_tr_b16 v[92:93], v21 offset:12288
  ds_read_b64_tr_b16 v[94:95], v21 offset:13312
  v_mfma_f32_32x32x16_bf16 v[96:111], v[40:43], v[72:75], v[96:111]
  v_mfma_f32_32x32x16_bf16 v[112:127], v[40:43], v[76:79], v[112:127]
  v_mfma_f32_32x32x16_bf16 v[128:143], v[44:47], v[72:75], v[128:143]
  v_mfma_f32_32x32x16_bf16 v[144:159], v[44:47], v[76:79], v[144:159]
  s_add_u32 s45, s45, 1
  s_cmp_eq_u32 s45, 4
  s_cselect_b32 s46, s47, s48
  s_cselect_b32 s45, 0, s45
  v_add_u32 v16, s46, v16
  v_add_u32 v17, s46, v17
  v_add_u32 v18, s46, v18
  v_add_u32 v19, s46, v19
  v_add_u32 v20, s46, v20
  v_add_u32 v21, s46, v21
  s_waitcnt lgkmcnt(0)
  s_mov_b32 s49, 1
concat_heads__ssm_conv_s4d__mha_block__prompt_kernel_gl1:
  s_barrier
  v_mfma_f32_32x32x16_bf16 v[96:111], v[48:51], v[80:83], v[96:111]
  ds_read_b128 v[32:35], v16 offset:0
  ds_read_b128 v[36:39], v16 offset:4096
  ds_read_b64_tr_b16 v[64:65], v20 offset:0
  v_mfma_f32_32x32x16_bf16 v[112:127], v[48:51], v[84:87], v[112:127]
  ds_read_b64_tr_b16 v[66:67], v20 offset:1024
  ds_read_b64_tr_b16 v[68:69], v21 offset:0
  ds_read_b64_tr_b16 v[70:71], v21 offset:1024
  v_mfma_f32_32x32x16_bf16 v[128:143], v[52:55], v[80:83], v[128:143]
  ds_read_b128 v[40:43], v17 offset:0
  ds_read_b128 v[44:47], v17 offset:4096
  ds_read_b64_tr_b16 v[72:73], v20 offset:4096
  v_mfma_f32_32x32x16_bf16 v[144:159], v[52:55], v[84:87], v[144:159]
  ds_read_b64_tr_b16 v[74:75], v20 offset:5120
  ds_read_b64_tr_b16 v[76:77], v21 offset:4096
  ds_read_b64_tr_b16 v[78:79], v21 offset:5120
  v_mfma_f32_32x32x16_bf16 v[96:111], v[56:59], v[88:91], v[96:111]
  v_mfma_f32_32x32x16_bf16 v[112:127], v[56:59], v[92:95], v[112:127]
  v_mfma_f32_32x32x16_bf16 v[128:143], v[60:63], v[88:91], v[128:143]
  v_mfma_f32_32x32x16_bf16 v[144:159], v[60:63], v[92:95], v[144:159]
  s_waitcnt lgkmcnt(0)
  v_mfma_f32_32x32x16_bf16 v[96:111], v[32:35], v[64:67], v[96:111]
  ds_read_b128 v[48:51], v18 offset:0
  ds_read_b128 v[52:55], v18 offset:4096
  ds_read_b64_tr_b16 v[80:81], v20 offset:8192
  v_mfma_f32_32x32x16_bf16 v[112:127], v[32:35], v[68:71], v[112:127]
  ds_read_b64_tr_b16 v[82:83], v20 offset:9216
  ds_read_b64_tr_b16 v[84:85], v21 offset:8192
  ds_read_b64_tr_b16 v[86:87], v21 offset:9216
  v_mfma_f32_32x32x16_bf16 v[128:143], v[36:39], v[64:67], v[128:143]
  ds_read_b128 v[56:59], v19 offset:0
  ds_read_b128 v[60:63], v19 offset:4096
  ds_read_b64_tr_b16 v[88:89], v20 offset:12288
  v_mfma_f32_32x32x16_bf16 v[144:159], v[36:39], v[68:71], v[144:159]
  ds_read_b64_tr_b16 v[90:91], v20 offset:13312
  ds_read_b64_tr_b16 v[92:93], v21 offset:12288
  ds_read_b64_tr_b16 v[94:95], v21 offset:13312
  v_mfma_f32_32x32x16_bf16 v[96:111], v[40:43], v[72:75], v[96:111]
  v_mfma_f32_32x32x16_bf16 v[112:127], v[40:43], v[76:79], v[112:127]
  v_mfma_f32_32x32x16_bf16 v[128:143], v[44:47], v[72:75], v[128:143]
  v_mfma_f32_32x32x16_bf16 v[144:159], v[44:47], v[76:79], v[144:159]
  s_add_u32 s45, s45, 1
  s_cmp_eq_u32 s45, 4
  s_cselect_b32 s46, s47, s48
  s_cselect_b32 s45, 0, s45
  v_add_u32 v16, s46, v16
  v_add_u32 v17, s46, v17
  v_add_u32 v18, s46, v18
  v_add_u32 v19, s46, v19
  v_add_u32 v20, s46, v20
  v_add_u32 v21, s46, v21
  s_add_u32 s49, s49, 1
  s_cmp_lt_u32 s49, 8
  s_waitcnt lgkmcnt(0)
  s_cbranch_scc1 concat_heads__ssm_conv_s4d__mha_block__prompt_kernel_gl1
  v_mfma_f32_32x32x16_bf16 v[96:111], v[48:51], v[80:83], v[96:111]
  v_mfma_f32_32x32x16_bf16 v[112:127], v[48:51], v[84:87], v[112:127]
  v_mfma_f32_32x32x16_bf16 v[128:143], v[52:55], v[80:83], v[128:143]
  v_mfma_f32_32x32x16_bf16 v[144:159], v[52:55], v[84:87], v[144:159]
  v_mfma_f32_32x32x16_bf16 v[96:111], v[56:59], v[88:91], v[96:111]
  v_mfma_f32_32x32x16_bf16 v[112:127], v[56:59], v[92:95], v[112:127]
  v_mfma_f32_32x32x16_bf16 v[128:143], v[60:63], v[88:91], v[128:143]
  v_mfma_f32_32x32x16_bf16 v[144:159], v[60:63], v[92:95], v[144:159]
  s_and_b32 s40, s26, 3
  s_lshl_b32 s40, s40, 3
  s_lshl_b32 s41, s36, 2
  s_add_u32 s40, s40, s41
  s_lshl_b32 s40, s40, 16
  s_lshl_b32 s41, s25, 12
  s_add_u32 s40, s40, s41
  s_lshl_b32 s41, s35, 11
  s_add_u32 s40, s40, s41
  s_mov_b32 s12, s8
  s_mov_b32 s13, s9
  s_mov_b32 s14, 33554432
  s_mov_b32 s15, 0x20000
  s_add_u32 s40, s40, 4194304
  v_bfe_u32 v6, v2, 4, 1
  v_lshlrev_b32 v6, 16, v6
  v_lshl_add_u32 v6, v8, 8, v6
  v_and_b32 v4, 15, v2
  v_lshl_add_u32 v6, v4, 4, v6
  s_nop 3
  v_cvt_pk_bf16_f32 v32, v96, v97
  v_cvt_pk_bf16_f32 v33, v98, v99
  v_cvt_pk_bf16_f32 v34, v100, v101
  v_cvt_pk_bf16_f32 v35, v102, v103
  v_cvt_pk_bf16_f32 v36, v104, v105
  v_cvt_pk_bf16_f32 v37, v106, v107
  v_cvt_pk_bf16_f32 v38, v108, v109
  v_cvt_pk_bf16_f32 v39, v110, v111
  s_add_u32 s44, s40, 0
  buffer_store_dwordx4 v[32:35], v6, s[12:15], s44 offen offset:0 sc0 sc1
  s_add_u32 s44, s40, 0
  buffer_store_dwordx4 v[36:39], v6, s[12:15], s44 offen offset:512 sc0 sc1
  v_cvt_pk_bf16_f32 v40, v112, v113
  v_cvt_pk_bf16_f32 v41, v114, v115
  v_cvt_pk_bf16_f32 v42, v116, v117
  v_cvt_pk_bf16_f32 v43, v118, v119
  v_cvt_pk_bf16_f32 v44, v120, v121
  v_cvt_pk_bf16_f32 v45, v122, v123
  v_cvt_pk_bf16_f32 v46, v124, v125
  v_cvt_pk_bf16_f32 v47, v126, v127
  s_add_u32 s44, s40, 131072
  buffer_store_dwordx4 v[40:43], v6, s[12:15], s44 offen offset:0 sc0 sc1
  s_add_u32 s44, s40, 131072
  buffer_store_dwordx4 v[44:47], v6, s[12:15], s44 offen offset:512 sc0 sc1
  v_cvt_pk_bf16_f32 v48, v128, v129
  v_cvt_pk_bf16_f32 v49, v130, v131
  v_cvt_pk_bf16_f32 v50, v132, v133
  v_cvt_pk_bf16_f32 v51, v134, v135
  v_cvt_pk_bf16_f32 v52, v136, v137
  v_cvt_pk_bf16_f32 v53, v138, v139
  v_cvt_pk_bf16_f32 v54, v140, v141
  v_cvt_pk_bf16_f32 v55, v142, v143
  s_add_u32 s44, s40, 1024
  buffer_store_dwordx4 v[48:51], v6, s[12:15], s44 offen offset:0 sc0 sc1
  s_add_u32 s44, s40, 1024
  buffer_store_dwordx4 v[52:55], v6, s[12:15], s44 offen offset:512 sc0 sc1
  v_cvt_pk_bf16_f32 v56, v144, v145
  v_cvt_pk_bf16_f32 v57, v146, v147
  v_cvt_pk_bf16_f32 v58, v148, v149
  v_cvt_pk_bf16_f32 v59, v150, v151
  v_cvt_pk_bf16_f32 v60, v152, v153
  v_cvt_pk_bf16_f32 v61, v154, v155
  v_cvt_pk_bf16_f32 v62, v156, v157
  v_cvt_pk_bf16_f32 v63, v158, v159
  s_add_u32 s44, s40, 132096
  buffer_store_dwordx4 v[56:59], v6, s[12:15], s44 offen offset:0 sc0 sc1
  s_add_u32 s44, s40, 132096
  buffer_store_dwordx4 v[60:63], v6, s[12:15], s44 offen offset:512 sc0 sc1
  s_branch concat_heads__ssm_conv_s4d__mha_block__prompt_kernel_s1
concat_heads__ssm_conv_s4d__mha_block__prompt_kernel_ut:
  s_load_dwordx2 s[56:57], s[0:1], 0
  s_sub_u32 s34, s2, 192
  s_lshr_b32 s36, s68, 2
  s_lshl_b32 s37, s34, 1
  s_add_u32 s37, s37, s36
  s_and_b32 s38, s37, 7
  s_lshr_b32 s39, s37, 3
  s_and_b32 s44, s68, 3
  v_lshrrev_b32 v12, 3, v2
  v_lshlrev_b32 v12, 10, v12
  v_and_b32 v13, 7, v2
  v_lshl_add_u32 v12, v13, 4, v12
  s_lshl_b32 s45, s39, 17
  s_lshl_b32 s46, s44, 15
  s_add_u32 s45, s45, s46
  s_lshl_b32 s46, s38, 7
  s_add_u32 s45, s45, s46
  s_lshl_b32 s46, s36, 14
  s_lshl_b32 s47, s44, 12
  s_add_u32 s46, s46, s47
  s_waitcnt lgkmcnt(0)
  s_mov_b32 s16, s56
  s_mov_b32 s17, s57
  s_mov_b32 s18, 2097152
  s_mov_b32 s19, 0x20000
  s_mov_b32 s12, s8
  s_mov_b32 s13, s9
  s_mov_b32 s14, 33554432
  s_mov_b32 s15, 0x20000
  s_add_u32 m0, s46, 0
  s_add_u32 s47, s45, 0
  buffer_load_dwordx4 v12, s[16:19], s47 offen lds
  s_add_u32 m0, s46, 1024
  s_add_u32 s47, s45, 8192
  buffer_load_dwordx4 v12, s[16:19], s47 offen lds
  s_add_u32 m0, s46, 2048
  s_add_u32 s47, s45, 16384
  buffer_load_dwordx4 v12, s[16:19], s47 offen lds
  s_add_u32 m0, s46, 3072
  s_add_u32 s47, s45, 24576
  buffer_load_dwordx4 v12, s[16:19], s47 offen lds
  s_mov_b32 s52, s38
  s_mov_b32 s53, s39
  s_mov_b32 s54, s44
  s_mov_b32 s55, s36
  s_load_dwordx8 s[40:47], s[0:1], 8
  s_load_dwordx2 s[48:49], s[0:1], 40
  s_lshr_b32 s50, s68, 2
  s_lshl_b32 s51, s2, 1
  s_add_u32 s50, s50, s51
  s_lshl_b32 s51, s50, 8
  s_bfe_u32 s71, s68, 0x10001
  s_lshl_b32 s71, s71, 7
  s_add_u32 s51, s51, s71
  v_lshlrev_b32 v4, 1, v2
  v_add_u32 v4, s51, v4
  s_lshr_b32 s50, s50, 1
  s_lshl_b32 s50, s50, 2
  s_waitcnt lgkmcnt(0)
  global_load_ushort v160, v4, s[40:41]
  global_load_ushort v161, v4, s[42:43]
  global_load_ushort v162, v4, s[44:45]
  global_load_ushort v163, v4, s[46:47]
  s_load_dword s70, s[48:49], s50
  v_lshrrev_b32 v5, 4, v2
  v_bfe_u32 v6, v2, 2, 2
  v_lshlrev_b32 v7, 5, v5
  v_lshl_add_u32 v7, v6, 2, v7
  v_lshlrev_b32 v7, 7, v7
  v_and_b32 v6, 3, v2
  v_lshl_add_u32 v7, v6, 3, v7
  s_lshl_b32 s46, s55, 14
  s_lshl_b32 s47, s54, 5
  s_add_u32 s46, s46, s47
  v_add_u32 v7, s46, v7
  v_and_b32 v8, 15, v2
  v_lshlrev_b32 v8, 12, v8
  v_lshl_add_u32 v8, v5, 4, v8
  s_lshl_b32 s45, s52, 18
  s_lshl_b32 s46, s54, 16
  s_add_u32 s45, s45, s46
  s_lshl_b32 s46, s53, 6
  s_add_u32 s45, s45, s46
  s_add_u32 s45, s45, 8388608
  s_waitcnt vmcnt(4)
  s_barrier
  ds_read_b64_tr_b16 v[20:21], v7 offset:0
  ds_read_b64_tr_b16 v[22:23], v7 offset:2048
  ds_read_b64_tr_b16 v[24:25], v7 offset:128
  ds_read_b64_tr_b16 v[26:27], v7 offset:2176
  ds_read_b64_tr_b16 v[28:29], v7 offset:256
  ds_read_b64_tr_b16 v[30:31], v7 offset:2304
  ds_read_b64_tr_b16 v[32:33], v7 offset:384
  ds_read_b64_tr_b16 v[34:35], v7 offset:2432
  s_waitcnt lgkmcnt(0)
  buffer_store_dwordx4 v[20:23], v8, s[12:15], s45 offen offset:0 sc0 sc1
  buffer_store_dwordx4 v[24:27], v8, s[12:15], s45 offen offset:1024 sc0 sc1
  buffer_store_dwordx4 v[28:31], v8, s[12:15], s45 offen offset:2048 sc0 sc1
  buffer_store_dwordx4 v[32:35], v8, s[12:15], s45 offen offset:3072 sc0 sc1
  s_branch concat_heads__ssm_conv_s4d__mha_block__prompt_kernel_s1
concat_heads__ssm_conv_s4d__mha_block__prompt_kernel_aux1:
  s_load_dwordx2 s[56:57], s[0:1], 88
  s_waitcnt lgkmcnt(0)
  s_mov_b32 s69, 0
  s_mov_b32 s61, 0
  s_cmp_eq_u32 s68, 11
  s_cbranch_scc0 concat_heads__ssm_conv_s4d__mha_block__prompt_kernel_aux1b
  s_cmp_eq_u32 s2, 0
  s_cbranch_scc0 concat_heads__ssm_conv_s4d__mha_block__prompt_kernel_aux1p
  v_mov_b32 v4, 25296896
  global_load_dword v5, v4, s[8:9] sc1
  s_waitcnt vmcnt(0)
  v_add_u32 v5, 1, v5
  v_mov_b32 v6, v5
  v_mov_b32 v7, 1
  v_mov_b32 v8, 0
  s_mov_b64 exec, 1
  global_store_dword v4, v5, s[8:9] sc0 sc1
  global_store_dwordx2 v8, v[6:7], s[56:57] sc0 sc1
  s_mov_b64 exec, -1
  v_readfirstlane_b32 s69, v5
  s_mov_b32 s61, 1
  s_branch concat_heads__ssm_conv_s4d__mha_block__prompt_kernel_aux1b
concat_heads__ssm_conv_s4d__mha_block__prompt_kernel_aux1p:
concat_heads__ssm_conv_s4d__mha_block__prompt_kernel_aux1b:
  s_cmp_ge_u32 s2, 192
  s_cbranch_scc1 concat_heads__ssm_conv_s4d__mha_block__prompt_kernel_aux1u
  s_barrier
  s_barrier
  s_barrier
  s_barrier
  s_mov_b32 s12, s8
  s_mov_b32 s13, s9
  s_mov_b32 s14, 33554432
  s_mov_b32 s15, 0x20000
  s_lshl_b32 s40, s27, 2
  s_bfe_u32 s41, s2, 0x20003
  s_add_u32 s40, s40, s41
  s_lshl_b32 s40, s40, 16
  s_lshr_b32 s41, s2, 5
  s_lshl_b32 s41, s41, 13
  s_add_u32 s40, s40, s41
  s_sub_u32 s41, s68, 8
  s_lshl_b32 s41, s41, 11
  s_add_u32 s40, s40, s41
  s_add_u32 s40, s40, 6291456
  v_mov_b32 v4, -1
  v_mov_b32 v5, -1
  v_mov_b32 v6, -1
  v_mov_b32 v7, -1
  buffer_store_dwordx4 v[4:7], v3, s[12:15], s40 offen sc0 sc1
  buffer_store_dwordx4 v[4:7], v3, s[12:15], s40 offen offset:1024 sc0 sc1
  s_nop 1
  s_barrier
  s_barrier
  s_barrier
  s_barrier
  s_branch concat_heads__ssm_conv_s4d__mha_block__prompt_kernel_aux1c
concat_heads__ssm_conv_s4d__mha_block__prompt_kernel_aux1u:
  s_mov_b32 s12, s8
  s_mov_b32 s13, s9
  s_mov_b32 s14, 33554432
  s_mov_b32 s15, 0x20000
  s_lshl_b32 s40, s27, 2
  s_bfe_u32 s41, s2, 0x20003
  s_add_u32 s40, s40, s41
  s_lshl_b32 s40, s40, 16
  s_lshr_b32 s41, s2, 5
  s_lshl_b32 s41, s41, 13
  s_add_u32 s40, s40, s41
  s_sub_u32 s41, s68, 8
  s_lshl_b32 s41, s41, 11
  s_add_u32 s40, s40, s41
  s_add_u32 s40, s40, 6291456
  v_mov_b32 v4, -1
  v_mov_b32 v5, -1
  v_mov_b32 v6, -1
  v_mov_b32 v7, -1
  buffer_store_dwordx4 v[4:7], v3, s[12:15], s40 offen sc0 sc1
  buffer_store_dwordx4 v[4:7], v3, s[12:15], s40 offen offset:1024 sc0 sc1
  s_nop 1
  s_barrier
concat_heads__ssm_conv_s4d__mha_block__prompt_kernel_aux1c:
  s_cmp_eq_u32 s68, 11
  s_cbranch_scc0 concat_heads__ssm_conv_s4d__mha_block__prompt_kernel_s1
  s_cmp_eq_u32 s61, 1
  s_cbranch_scc1 concat_heads__ssm_conv_s4d__mha_block__prompt_kernel_pub
  s_mov_b32 s62, 0
  v_mov_b32 v8, 0
concat_heads__ssm_conv_s4d__mha_block__prompt_kernel_nq2:
  global_load_dwordx2 v[6:7], v8, s[56:57] sc1
  s_waitcnt vmcnt(0)
  v_readfirstlane_b32 s61, v7
  v_readfirstlane_b32 s69, v6
  s_add_u32 s62, s62, 1
  s_cmp_eq_u32 s61, 1
  s_cbranch_scc1 concat_heads__ssm_conv_s4d__mha_block__prompt_kernel_nq2_x
  s_cmp_lt_u32 s62, 100000
  s_cbranch_scc1 concat_heads__ssm_conv_s4d__mha_block__prompt_kernel_nq2
concat_heads__ssm_conv_s4d__mha_block__prompt_kernel_nq2_x:
concat_heads__ssm_conv_s4d__mha_block__prompt_kernel_pub:
  v_mov_b32 v4, 151848
  v_mov_b32 v5, s69
  v_mov_b32 v6, 0
  ds_write_b32 v4, v5
  ds_write_b32 v4, v6 offset:8
  ds_write_b32 v4, v6 offset:88
  ds_write_b32 v4, v6 offset:92
  ds_write_b32 v4, v6 offset:96
  ds_write_b32 v4, v6 offset:100
concat_heads__ssm_conv_s4d__mha_block__prompt_kernel_s1:
  s_mov_b32 s12, s8
  s_mov_b32 s13, s9
  s_mov_b32 s14, 33554432
  s_mov_b32 s15, 0x20000
  s_waitcnt vmcnt(0) lgkmcnt(0)
  s_barrier
  s_cmp_ge_u32 s68, 8
  s_cbranch_scc1 concat_heads__ssm_conv_s4d__mha_block__prompt_kernel_aux2
  s_lshr_b32 s40, s68, 2
  s_bfe_u32 s41, s68, 0x10001
  s_mul_i32 s42, s40, 32768
  s_mul_i32 s43, s41, 14416
  s_add_u32 s42, s42, s43
  s_add_u32 s42, s42, 65536
  v_lshlrev_b32 v15, 2, v2
  v_add_u32 v15, s42, v15
  s_lshr_b32 s43, s68, 2
  s_lshl_b32 s44, s70, 16
  s_and_b32 s45, s70, 0xffff0000
  s_cmp_eq_u32 s43, 0
  s_cselect_b32 s44, s44, s45
  s_mov_b32 s46, 0x3fb8aa3b
  v_mov_b32 v14, s44
  v_mul_f32 v14, s46, v14
  v_exp_f32 v14, v14
  v_lshlrev_b32 v40, 16, v160
  v_cvt_pk_bf16_f32 v14, v14, v14
  v_lshlrev_b32 v14, 16, v14
  v_lshlrev_b32 v41, 16, v161
  v_mul_f32 v40, s46, v40
  v_exp_f32 v40, v40
  v_mul_f32 v41, v41, v14
  v_cvt_pk_bf16_f32 v40, v40, v40
  v_lshlrev_b32 v40, 16, v40
  v_mul_f32 v40, v40, v14
  v_mul_f32 v40, 0xbfb8aa3b, v40
  v_mul_f32 v41, 0x3e22f983, v41
  s_and_b32 s43, s68, 1
  s_cmp_eq_u32 s43, 0
  s_cbranch_scc0 concat_heads__ssm_conv_s4d__mha_block__prompt_kernel_xtab
  v_mul_f32 v44, 0x41000000, v40
  v_mul_f32 v45, 0x41000000, v41
  v_exp_f32 v44, v44
  v_fract_f32 v45, v45
  v_cos_f32 v46, v45
  v_sin_f32 v47, v45
  s_nop 0
  v_mul_f32 v22, v44, v46
  v_mul_f32 v23, v44, v47
  v_pk_mul_f32 v[38:39], v[22:23], v[22:23] op_sel:[0,0] op_sel_hi:[0,1]
  v_pk_fma_f32 v[26:27], v[22:23], v[22:23], v[38:39] op_sel:[1,1,0] op_sel_hi:[1,0,1] neg_lo:[1,0,0]
  v_mov_b32 v32, 1.0
  v_mov_b32 v33, 0
  v_mov_b32 v34, v22
  v_mov_b32 v35, v23
  v_cvt_pk_bf16_f32 v60, v32, v33
  ds_write_b32 v15, v60 offset:5712
  v_cvt_pk_bf16_f32 v61, v34, v35
  ds_write_b32 v15, v61 offset:5984
  v_pk_mul_f32 v[38:39], v[32:33], v[26:27] op_sel:[0,0] op_sel_hi:[0,1]
  v_pk_fma_f32 v[36:37], v[32:33], v[26:27], v[38:39] op_sel:[1,1,0] op_sel_hi:[1,0,1] neg_lo:[1,0,0]
  v_pk_mul_f32 v[40:41], v[34:35], v[26:27] op_sel:[0,0] op_sel_hi:[0,1]
  v_pk_fma_f32 v[50:51], v[34:35], v[26:27], v[40:41] op_sel:[1,1,0] op_sel_hi:[1,0,1] neg_lo:[1,0,0]
  v_cvt_pk_bf16_f32 v62, v36, v37
  ds_write_b32 v15, v62 offset:6256
  v_cvt_pk_bf16_f32 v63, v50, v51
  ds_write_b32 v15, v63 offset:6528
  v_pk_mul_f32 v[38:39], v[36:37], v[26:27] op_sel:[0,0] op_sel_hi:[0,1]
  v_pk_fma_f32 v[32:33], v[36:37], v[26:27], v[38:39] op_sel:[1,1,0] op_sel_hi:[1,0,1] neg_lo:[1,0,0]
  v_pk_mul_f32 v[40:41], v[50:51], v[26:27] op_sel:[0,0] op_sel_hi:[0,1]
  v_pk_fma_f32 v[34:35], v[50:51], v[26:27], v[40:41] op_sel:[1,1,0] op_sel_hi:[1,0,1] neg_lo:[1,0,0]
  v_cvt_pk_bf16_f32 v60, v32, v33
  ds_write_b32 v15, v60 offset:6800
  v_cvt_pk_bf16_f32 v61, v34, v35
  ds_write_b32 v15, v61 offset:7072
  v_pk_mul_f32 v[38:39], v[32:33], v[26:27] op_sel:[0,0] op_sel_hi:[0,1]
  v_pk_fma_f32 v[36:37], v[32:33], v[26:27], v[38:39] op_sel:[1,1,0] op_sel_hi:[1,0,1] neg_lo:[1,0,0]
  v_pk_mul_f32 v[40:41], v[34:35], v[26:27] op_sel:[0,0] op_sel_hi:[0,1]
  v_pk_fma_f32 v[50:51], v[34:35], v[26:27], v[40:41] op_sel:[1,1,0] op_sel_hi:[1,0,1] neg_lo:[1,0,0]
  v_cvt_pk_bf16_f32 v62, v36, v37
  ds_write_b32 v15, v62 offset:7344
  v_cvt_pk_bf16_f32 v63, v50, v51
  ds_write_b32 v15, v63 offset:7616
  v_pk_mul_f32 v[38:39], v[36:37], v[26:27] op_sel:[0,0] op_sel_hi:[0,1]
  v_pk_fma_f32 v[32:33], v[36:37], v[26:27], v[38:39] op_sel:[1,1,0] op_sel_hi:[1,0,1] neg_lo:[1,0,0]
  v_pk_mul_f32 v[40:41], v[50:51], v[26:27] op_sel:[0,0] op_sel_hi:[0,1]
  v_pk_fma_f32 v[34:35], v[50:51], v[26:27], v[40:41] op_sel:[1,1,0] op_sel_hi:[1,0,1] neg_lo:[1,0,0]
  v_cvt_pk_bf16_f32 v60, v32, v33
  ds_write_b32 v15, v60 offset:7888
  v_cvt_pk_bf16_f32 v61, v34, v35
  ds_write_b32 v15, v61 offset:8160
  v_pk_mul_f32 v[38:39], v[32:33], v[26:27] op_sel:[0,0] op_sel_hi:[0,1]
  v_pk_fma_f32 v[36:37], v[32:33], v[26:27], v[38:39] op_sel:[1,1,0] op_sel_hi:[1,0,1] neg_lo:[1,0,0]
  v_pk_mul_f32 v[40:41], v[34:35], v[26:27] op_sel:[0,0] op_sel_hi:[0,1]
  v_pk_fma_f32 v[50:51], v[34:35], v[26:27], v[40:41] op_sel:[1,1,0] op_sel_hi:[1,0,1] neg_lo:[1,0,0]
  v_cvt_pk_bf16_f32 v62, v36, v37
  ds_write_b32 v15, v62 offset:8432
  v_cvt_pk_bf16_f32 v63, v50, v51
  ds_write_b32 v15, v63 offset:8704
  v_pk_mul_f32 v[38:39], v[36:37], v[26:27] op_sel:[0,0] op_sel_hi:[0,1]
  v_pk_fma_f32 v[32:33], v[36:37], v[26:27], v[38:39] op_sel:[1,1,0] op_sel_hi:[1,0,1] neg_lo:[1,0,0]
  v_pk_mul_f32 v[40:41], v[50:51], v[26:27] op_sel:[0,0] op_sel_hi:[0,1]
  v_pk_fma_f32 v[34:35], v[50:51], v[26:27], v[40:41] op_sel:[1,1,0] op_sel_hi:[1,0,1] neg_lo:[1,0,0]
  v_cvt_pk_bf16_f32 v60, v32, v33
  ds_write_b32 v15, v60 offset:8976
  v_cvt_pk_bf16_f32 v61, v34, v35
  ds_write_b32 v15, v61 offset:9248
  v_pk_mul_f32 v[38:39], v[32:33], v[26:27] op_sel:[0,0] op_sel_hi:[0,1]
  v_pk_fma_f32 v[36:37], v[32:33], v[26:27], v[38:39] op_sel:[1,1,0] op_sel_hi:[1,0,1] neg_lo:[1,0,0]
  v_pk_mul_f32 v[40:41], v[34:35], v[26:27] op_sel:[0,0] op_sel_hi:[0,1]
  v_pk_fma_f32 v[50:51], v[34:35], v[26:27], v[40:41] op_sel:[1,1,0] op_sel_hi:[1,0,1] neg_lo:[1,0,0]
  v_cvt_pk_bf16_f32 v62, v36, v37
  ds_write_b32 v15, v62 offset:9520
  v_cvt_pk_bf16_f32 v63, v50, v51
  ds_write_b32 v15, v63 offset:9792
  v_pk_mul_f32 v[38:39], v[36:37], v[26:27] op_sel:[0,0] op_sel_hi:[0,1]
  v_pk_fma_f32 v[32:33], v[36:37], v[26:27], v[38:39] op_sel:[1,1,0] op_sel_hi:[1,0,1] neg_lo:[1,0,0]
  v_pk_mul_f32 v[40:41], v[50:51], v[26:27] op_sel:[0,0] op_sel_hi:[0,1]
  v_pk_fma_f32 v[34:35], v[50:51], v[26:27], v[40:41] op_sel:[1,1,0] op_sel_hi:[1,0,1] neg_lo:[1,0,0]
  v_cvt_pk_bf16_f32 v60, v32, v33
  ds_write_b32 v15, v60 offset:10064
  v_cvt_pk_bf16_f32 v61, v34, v35
  ds_write_b32 v15, v61 offset:10336
  v_pk_mul_f32 v[38:39], v[32:33], v[26:27] op_sel:[0,0] op_sel_hi:[0,1]
  v_pk_fma_f32 v[36:37], v[32:33], v[26:27], v[38:39] op_sel:[1,1,0] op_sel_hi:[1,0,1] neg_lo:[1,0,0]
  v_pk_mul_f32 v[40:41], v[34:35], v[26:27] op_sel:[0,0] op_sel_hi:[0,1]
  v_pk_fma_f32 v[50:51], v[34:35], v[26:27], v[40:41] op_sel:[1,1,0] op_sel_hi:[1,0,1] neg_lo:[1,0,0]
  v_cvt_pk_bf16_f32 v62, v36, v37
  ds_write_b32 v15, v62 offset:10608
  v_cvt_pk_bf16_f32 v63, v50, v51
  ds_write_b32 v15, v63 offset:10880
  v_pk_mul_f32 v[38:39], v[36:37], v[26:27] op_sel:[0,0] op_sel_hi:[0,1]
  v_pk_fma_f32 v[32:33], v[36:37], v[26:27], v[38:39] op_sel:[1,1,0] op_sel_hi:[1,0,1] neg_lo:[1,0,0]
  v_pk_mul_f32 v[40:41], v[50:51], v[26:27] op_sel:[0,0] op_sel_hi:[0,1]
  v_pk_fma_f32 v[34:35], v[50:51], v[26:27], v[40:41] op_sel:[1,1,0] op_sel_hi:[1,0,1] neg_lo:[1,0,0]
  v_cvt_pk_bf16_f32 v60, v32, v33
  ds_write_b32 v15, v60 offset:11152
  v_cvt_pk_bf16_f32 v61, v34, v35
  ds_write_b32 v15, v61 offset:11424
  v_pk_mul_f32 v[38:39], v[32:33], v[26:27] op_sel:[0,0] op_sel_hi:[0,1]
  v_pk_fma_f32 v[36:37], v[32:33], v[26:27], v[38:39] op_sel:[1,1,0] op_sel_hi:[1,0,1] neg_lo:[1,0,0]
  v_pk_mul_f32 v[40:41], v[34:35], v[26:27] op_sel:[0,0] op_sel_hi:[0,1]
  v_pk_fma_f32 v[50:51], v[34:35], v[26:27], v[40:41] op_sel:[1,1,0] op_sel_hi:[1,0,1] neg_lo:[1,0,0]
  v_cvt_pk_bf16_f32 v62, v36, v37
  ds_write_b32 v15, v62 offset:11696
  v_cvt_pk_bf16_f32 v63, v50, v51
  ds_write_b32 v15, v63 offset:11968
  v_pk_mul_f32 v[38:39], v[36:37], v[26:27] op_sel:[0,0] op_sel_hi:[0,1]
  v_pk_fma_f32 v[32:33], v[36:37], v[26:27], v[38:39] op_sel:[1,1,0] op_sel_hi:[1,0,1] neg_lo:[1,0,0]
  v_pk_mul_f32 v[40:41], v[50:51], v[26:27] op_sel:[0,0] op_sel_hi:[0,1]
  v_pk_fma_f32 v[34:35], v[50:51], v[26:27], v[40:41] op_sel:[1,1,0] op_sel_hi:[1,0,1] neg_lo:[1,0,0]
  v_cvt_pk_bf16_f32 v60, v32, v33
  ds_write_b32 v15, v60 offset:12240
  v_cvt_pk_bf16_f32 v61, v34, v35
  ds_write_b32 v15, v61 offset:12512
  v_pk_mul_f32 v[38:39], v[32:33], v[26:27] op_sel:[0,0] op_sel_hi:[0,1]
  v_pk_fma_f32 v[36:37], v[32:33], v[26:27], v[38:39] op_sel:[1,1,0] op_sel_hi:[1,0,1] neg_lo:[1,0,0]
  v_pk_mul_f32 v[40:41], v[34:35], v[26:27] op_sel:[0,0] op_sel_hi:[0,1]
  v_pk_fma_f32 v[50:51], v[34:35], v[26:27], v[40:41] op_sel:[1,1,0] op_sel_hi:[1,0,1] neg_lo:[1,0,0]
  v_cvt_pk_bf16_f32 v62, v36, v37
  ds_write_b32 v15, v62 offset:12784
  v_cvt_pk_bf16_f32 v63, v50, v51
  ds_write_b32 v15, v63 offset:13056
  v_pk_mul_f32 v[38:39], v[36:37], v[26:27] op_sel:[0,0] op_sel_hi:[0,1]
  v_pk_fma_f32 v[32:33], v[36:37], v[26:27], v[38:39] op_sel:[1,1,0] op_sel_hi:[1,0,1] neg_lo:[1,0,0]
  v_pk_mul_f32 v[40:41], v[50:51], v[26:27] op_sel:[0,0] op_sel_hi:[0,1]
  v_pk_fma_f32 v[34:35], v[50:51], v[26:27], v[40:41] op_sel:[1,1,0] op_sel_hi:[1,0,1] neg_lo:[1,0,0]
  v_cvt_pk_bf16_f32 v60, v32, v33
  ds_write_b32 v15, v60 offset:13328
  v_cvt_pk_bf16_f32 v61, v34, v35
  ds_write_b32 v15, v61 offset:13600
  v_pk_mul_f32 v[38:39], v[32:33], v[26:27] op_sel:[0,0] op_sel_hi:[0,1]
  v_pk_fma_f32 v[36:37], v[32:33], v[26:27], v[38:39] op_sel:[1,1,0] op_sel_hi:[1,0,1] neg_lo:[1,0,0]
  v_pk_mul_f32 v[40:41], v[34:35], v[26:27] op_sel:[0,0] op_sel_hi:[0,1]
  v_pk_fma_f32 v[50:51], v[34:35], v[26:27], v[40:41] op_sel:[1,1,0] op_sel_hi:[1,0,1] neg_lo:[1,0,0]
  v_cvt_pk_bf16_f32 v62, v36, v37
  ds_write_b32 v15, v62 offset:13872
  v_cvt_pk_bf16_f32 v63, v50, v51
  ds_write_b32 v15, v63 offset:14144
  s_branch concat_heads__ssm_conv_s4d__mha_block__prompt_kernel_tabdone
concat_heads__ssm_conv_s4d__mha_block__prompt_kernel_xtab:
  v_lshlrev_b32 v42, 16, v162
  v_lshlrev_b32 v43, 16, v163
  v_mul_f32 v30, v42, v14
  v_mul_f32 v31, v43, v14
  v_add_f32 v30, v30, v30
  v_add_f32 v31, v31, v31
  v_mul_f32 v44, 0x3f800000, v40
  v_mul_f32 v45, 0x3f800000, v41
  v_exp_f32 v44, v44
  v_fract_f32 v45, v45
  v_cos_f32 v46, v45
  v_sin_f32 v47, v45
  s_nop 0
  v_mul_f32 v20, v44, v46
  v_mul_f32 v21, v44, v47
  v_mul_f32 v44, 0x43800000, v40
  v_mul_f32 v45, 0x43800000, v41
  v_exp_f32 v44, v44
  v_fract_f32 v45, v45
  v_cos_f32 v46, v45
  v_sin_f32 v47, v45
  s_nop 0
  v_mul_f32 v24, v44, v46
  v_mul_f32 v25, v44, v47
  v_pk_mul_f32 v[38:39], v[20:21], v[20:21] op_sel:[0,0] op_sel_hi:[0,1]
  v_pk_fma_f32 v[26:27], v[20:21], v[20:21], v[38:39] op_sel:[1,1,0] op_sel_hi:[1,0,1] neg_lo:[1,0,0]
  v_pk_mul_f32 v[38:39], v[26:27], v[26:27] op_sel:[0,0] op_sel_hi:[0,1]
  v_pk_fma_f32 v[28:29], v[26:27], v[26:27], v[38:39] op_sel:[1,1,0] op_sel_hi:[1,0,1] neg_lo:[1,0,0]
  v_cvt_pk_bf16_f32 v60, v30, -v31
  ds_write_b32 v15, v60 offset:0
  v_pk_mul_f32 v[38:39], v[30:31], v[20:21] op_sel:[0,0] op_sel_hi:[0,1]
  v_pk_fma_f32 v[50:51], v[30:31], v[20:21], v[38:39] op_sel:[1,1,0] op_sel_hi:[1,0,1] neg_lo:[1,0,0]
  v_cvt_pk_bf16_f32 v61, v50, -v51
  ds_write_b32 v15, v61 offset:272
  v_pk_mul_f32 v[40:41], v[30:31], v[24:25] op_sel:[0,0] op_sel_hi:[0,1]
  v_pk_fma_f32 v[54:55], v[30:31], v[24:25], v[40:41] op_sel:[1,1,0] op_sel_hi:[1,0,1] neg_lo:[1,0,0]
  v_cvt_pk_bf16_f32 v62, v54, -v55
  ds_write_b32 v15, v62 offset:2176
  v_pk_mul_f32 v[38:39], v[50:51], v[20:21] op_sel:[0,0] op_sel_hi:[0,1]
  v_pk_fma_f32 v[52:53], v[50:51], v[20:21], v[38:39] op_sel:[1,1,0] op_sel_hi:[1,0,1] neg_lo:[1,0,0]
  v_cvt_pk_bf16_f32 v63, v52, -v53
  ds_write_b32 v15, v63 offset:544
  v_pk_mul_f32 v[40:41], v[54:55], v[26:27] op_sel:[0,0] op_sel_hi:[0,1]
  v_pk_fma_f32 v[58:59], v[54:55], v[26:27], v[40:41] op_sel:[1,1,0] op_sel_hi:[1,0,1] neg_lo:[1,0,0]
  v_cvt_pk_bf16_f32 v60, v58, -v59
  ds_write_b32 v15, v60 offset:2448
  v_pk_mul_f32 v[38:39], v[52:53], v[20:21] op_sel:[0,0] op_sel_hi:[0,1]
  v_pk_fma_f32 v[50:51], v[52:53], v[20:21], v[38:39] op_sel:[1,1,0] op_sel_hi:[1,0,1] neg_lo:[1,0,0]
  v_cvt_pk_bf16_f32 v61, v50, -v51
  ds_write_b32 v15, v61 offset:816
  v_pk_mul_f32 v[40:41], v[58:59], v[26:27] op_sel:[0,0] op_sel_hi:[0,1]
  v_pk_fma_f32 v[32:33], v[58:59], v[26:27], v[40:41] op_sel:[1,1,0] op_sel_hi:[1,0,1] neg_lo:[1,0,0]
  v_cvt_pk_bf16_f32 v62, v32, -v33
  ds_write_b32 v15, v62 offset:2720
  v_pk_mul_f32 v[38:39], v[50:51], v[20:21] op_sel:[0,0] op_sel_hi:[0,1]
  v_pk_fma_f32 v[52:53], v[50:51], v[20:21], v[38:39] op_sel:[1,1,0] op_sel_hi:[1,0,1] neg_lo:[1,0,0]
  v_cvt_pk_bf16_f32 v63, v52, -v53
  ds_write_b32 v15, v63 offset:1088
  v_pk_mul_f32 v[40:41], v[32:33], v[26:27] op_sel:[0,0] op_sel_hi:[0,1]
  v_pk_fma_f32 v[58:59], v[32:33], v[26:27], v[40:41] op_sel:[1,1,0] op_sel_hi:[1,0,1] neg_lo:[1,0,0]
  v_cvt_pk_bf16_f32 v60, v58, -v59
  ds_write_b32 v15, v60 offset:2992
  v_pk_mul_f32 v[38:39], v[52:53], v[20:21] op_sel:[0,0] op_sel_hi:[0,1]
  v_pk_fma_f32 v[50:51], v[52:53], v[20:21], v[38:39] op_sel:[1,1,0] op_sel_hi:[1,0,1] neg_lo:[1,0,0]
  v_cvt_pk_bf16_f32 v61, v50, -v51
  ds_write_b32 v15, v61 offset:1360
  v_pk_mul_f32 v[40:41], v[54:55], v[24:25] op_sel:[0,0] op_sel_hi:[0,1]
  v_pk_fma_f32 v[56:57], v[54:55], v[24:25], v[40:41] op_sel:[1,1,0] op_sel_hi:[1,0,1] neg_lo:[1,0,0]
  v_cvt_pk_bf16_f32 v62, v56, -v57
  ds_write_b32 v15, v62 offset:3264
  v_pk_mul_f32 v[38:39], v[50:51], v[20:21] op_sel:[0,0] op_sel_hi:[0,1]
  v_pk_fma_f32 v[52:53], v[50:51], v[20:21], v[38:39] op_sel:[1,1,0] op_sel_hi:[1,0,1] neg_lo:[1,0,0]
  v_cvt_pk_bf16_f32 v63, v52, -v53
  ds_write_b32 v15, v63 offset:1632
  v_pk_mul_f32 v[40:41], v[56:57], v[28:29] op_sel:[0,0] op_sel_hi:[0,1]
  v_pk_fma_f32 v[58:59], v[56:57], v[28:29], v[40:41] op_sel:[1,1,0] op_sel_hi:[1,0,1] neg_lo:[1,0,0]
  v_cvt_pk_bf16_f32 v60, v58, -v59
  ds_write_b32 v15, v60 offset:3536
  v_pk_mul_f32 v[38:39], v[52:53], v[20:21] op_sel:[0,0] op_sel_hi:[0,1]
  v_pk_fma_f32 v[50:51], v[52:53], v[20:21], v[38:39] op_sel:[1,1,0] op_sel_hi:[1,0,1] neg_lo:[1,0,0]
  v_cvt_pk_bf16_f32 v61, v50, -v51
  ds_write_b32 v15, v61 offset:1904
  v_pk_mul_f32 v[40:41], v[56:57], v[24:25] op_sel:[0,0] op_sel_hi:[0,1]
  v_pk_fma_f32 v[54:55], v[56:57], v[24:25], v[40:41] op_sel:[1,1,0] op_sel_hi:[1,0,1] neg_lo:[1,0,0]
  v_cvt_pk_bf16_f32 v62, v54, -v55
  ds_write_b32 v15, v62 offset:3808
  v_pk_mul_f32 v[40:41], v[54:55], v[28:29] op_sel:[0,0] op_sel_hi:[0,1]
  v_pk_fma_f32 v[58:59], v[54:55], v[28:29], v[40:41] op_sel:[1,1,0] op_sel_hi:[1,0,1] neg_lo:[1,0,0]
  v_cvt_pk_bf16_f32 v63, v58, -v59
  ds_write_b32 v15, v63 offset:4080
  v_pk_mul_f32 v[40:41], v[54:55], v[24:25] op_sel:[0,0] op_sel_hi:[0,1]
  v_pk_fma_f32 v[56:57], v[54:55], v[24:25], v[40:41] op_sel:[1,1,0] op_sel_hi:[1,0,1] neg_lo:[1,0,0]
  v_cvt_pk_bf16_f32 v60, v56, -v57
  ds_write_b32 v15, v60 offset:4352
  v_pk_mul_f32 v[40:41], v[56:57], v[24:25] op_sel:[0,0] op_sel_hi:[0,1]
  v_pk_fma_f32 v[54:55], v[56:57], v[24:25], v[40:41] op_sel:[1,1,0] op_sel_hi:[1,0,1] neg_lo:[1,0,0]
  v_cvt_pk_bf16_f32 v61, v54, -v55
  ds_write_b32 v15, v61 offset:4624
  v_pk_mul_f32 v[40:41], v[54:55], v[24:25] op_sel:[0,0] op_sel_hi:[0,1]
  v_pk_fma_f32 v[56:57], v[54:55], v[24:25], v[40:41] op_sel:[1,1,0] op_sel_hi:[1,0,1] neg_lo:[1,0,0]
  v_cvt_pk_bf16_f32 v62, v56, -v57
  ds_write_b32 v15, v62 offset:4896
  v_pk_mul_f32 v[40:41], v[56:57], v[24:25] op_sel:[0,0] op_sel_hi:[0,1]
  v_pk_fma_f32 v[54:55], v[56:57], v[24:25], v[40:41] op_sel:[1,1,0] op_sel_hi:[1,0,1] neg_lo:[1,0,0]
  v_cvt_pk_bf16_f32 v63, v54, -v55
  ds_write_b32 v15, v63 offset:5168
  v_pk_mul_f32 v[40:41], v[54:55], v[24:25] op_sel:[0,0] op_sel_hi:[0,1]
  v_pk_fma_f32 v[56:57], v[54:55], v[24:25], v[40:41] op_sel:[1,1,0] op_sel_hi:[1,0,1] neg_lo:[1,0,0]
  v_cvt_pk_bf16_f32 v60, v56, -v57
  ds_write_b32 v15, v60 offset:5440
concat_heads__ssm_conv_s4d__mha_block__prompt_kernel_tabdone:
  s_waitcnt lgkmcnt(0)
  s_branch concat_heads__ssm_conv_s4d__mha_block__prompt_kernel_t1
concat_heads__ssm_conv_s4d__mha_block__prompt_kernel_aux2:
  s_cmp_eq_u32 s68, 11
  s_cbranch_scc0 concat_heads__ssm_conv_s4d__mha_block__prompt_kernel_t1
  s_lshl_b32 s40, s2, 7
  s_add_u32 s40, s40, 25165824
  v_mov_b32 v4, s40
  v_mov_b32 v5, s69
  s_mov_b64 exec, 1
  global_store_dword v4, v5, s[8:9] sc0 sc1
  s_mov_b64 exec, -1
  s_lshl_b32 s41, s27, 2
  s_bfe_u32 s42, s2, 0x20003
  s_add_u32 s41, s41, s42
  s_lshr_b32 s41, s41, 3
  v_and_b32 v4, 15, v2
  v_lshrrev_b32 v5, 4, v2
  v_lshlrev_b32 v5, 2, v5
  v_add_u32 v5, s41, v5
  v_cmp_le_u32 vcc, 6, v5
  v_lshrrev_b32 v6, 2, v4
  v_and_b32 v7, 3, v4
  v_cndmask_b32 v8, 0, 1, vcc
  v_mul_u32_u24 v9, 6, v8
  v_sub_u32 v9, v5, v9
  v_lshl_add_u32 v6, v8, 2, v6
  v_lshl_add_u32 v7, v9, 2, v7
  v_lshl_add_u32 v6, v7, 3, v6
  s_lshr_b32 s42, s2, 5
  s_lshr_b32 s42, s42, 1
  s_add_u32 s42, s42, 192
  v_subrev_u32 v9, 48, v2
  v_lshlrev_b32 v9, 2, v9
  v_add_u32 v9, s42, v9
  v_cmp_le_u32 vcc, 48, v2
  s_nop 1
  v_cndmask_b32 v6, v6, v9, vcc
  v_lshlrev_b32 v6, 7, v6
  v_add_u32 v6, 25165824, v6
  s_barrier
  s_mov_b32 s62, 0
  global_load_dword v150, v6, s[8:9] sc1
  s_nop 7
  global_load_dword v151, v6, s[8:9] sc1
concat_heads__ssm_conv_s4d__mha_block__prompt_kernel_fp1:
  global_load_dword v152, v6, s[8:9] sc1
  s_waitcnt vmcnt(2)
  v_cmp_ne_u32 vcc, s69, v150
  s_cmp_eq_u64 vcc, 0
  s_cbranch_scc1 concat_heads__ssm_conv_s4d__mha_block__prompt_kernel_fp1_x
  global_load_dword v150, v6, s[8:9] sc1
  s_waitcnt vmcnt(2)
  v_cmp_ne_u32 vcc, s69, v151
  s_cmp_eq_u64 vcc, 0
  s_cbranch_scc1 concat_heads__ssm_conv_s4d__mha_block__prompt_kernel_fp1_x
  global_load_dword v151, v6, s[8:9] sc1
  s_waitcnt vmcnt(2)
  v_cmp_ne_u32 vcc, s69, v152
  s_cmp_eq_u64 vcc, 0
  s_cbranch_scc1 concat_heads__ssm_conv_s4d__mha_block__prompt_kernel_fp1_x
  s_add_u32 s62, s62, 1
  s_cmp_lt_u32 s62, 100000
  s_cbranch_scc1 concat_heads__ssm_conv_s4d__mha_block__prompt_kernel_fp1
concat_heads__ssm_conv_s4d__mha_block__prompt_kernel_fp1_x:
  v_mov_b32 v4, 151856
  v_mov_b32 v5, 1
  ds_write_b32 v4, v5
  s_branch concat_heads__ssm_conv_s4d__mha_block__prompt_kernel_s2
concat_heads__ssm_conv_s4d__mha_block__prompt_kernel_t1:
  s_barrier
concat_heads__ssm_conv_s4d__mha_block__prompt_kernel_s2:
  s_mov_b32 s24, s68
  s_lshl_b32 s25, s27, 2
  s_bfe_u32 s29, s2, 0x20003
  s_add_u32 s25, s25, s29
  s_lshl_b32 s30, s25, 16
  s_lshr_b32 s26, s2, 5
  s_mov_b32 s60, 0
  s_cmp_ge_u32 s24, 8
  s_cbranch_scc1 concat_heads__ssm_conv_s4d__mha_block__prompt_kernel_conv
  s_and_b32 s28, s24, 1
  s_lshr_b32 s29, s24, 1
  s_mov_b32 s20, 0xffff
  s_mov_b32 s21, 0xffff
  s_lshl_b32 s31, s26, 13
  s_lshl_b32 s32, s28, 12
  s_add_u32 s31, s31, s32
  s_add_u32 s31, s31, s30
  s_lshl_b32 s37, s29, 14
  s_add_u32 s35, s37, s30
  v_lshrrev_b32 v14, 5, v2
  v_lshlrev_b32 v14, 8, v14
  v_and_b32 v15, 15, v2
  v_lshl_add_u32 v11, v15, 4, v14
  v_mov_b32 v9, 151856
  s_mov_b32 s62, 0
concat_heads__ssm_conv_s4d__mha_block__prompt_kernel_wr0:
  ds_read_b32 v8, v9
  s_waitcnt lgkmcnt(0)
  v_readfirstlane_b32 s63, v8
  s_add_u32 s62, s62, 1
  s_cmp_eq_u32 s63, 1
  s_cbranch_scc1 concat_heads__ssm_conv_s4d__mha_block__prompt_kernel_wr0_x
  s_sleep 1
  s_cmp_lt_u32 s62, 0x400000
  s_cbranch_scc1 concat_heads__ssm_conv_s4d__mha_block__prompt_kernel_wr0
concat_heads__ssm_conv_s4d__mha_block__prompt_kernel_wr0_x:
concat_heads__ssm_conv_s4d__mha_block__prompt_kernel_restart:
  s_add_u32 s33, s31, 0
  s_add_u32 s34, s35, 2097152
  s_add_u32 s36, s35, 4194304
  buffer_load_dwordx4 v[128:131], v3, s[12:15], s34 offen sc1
  buffer_load_dwordx4 v[112:115], v3, s[12:15], s33 offen sc1
  v_and_b32 v14, 31, v2
  v_cmp_eq_u32 vcc, 16, v14
  v_mov_b32 v14, 0x3f803f80
  v_mov_b32 v15, 0
  v_cndmask_b32 v136, v15, v14, vcc
  v_mov_b32 v137, v136
  v_mov_b32 v138, v136
  v_mov_b32 v139, v136
  v_mov_b32 v140, v136
  v_mov_b32 v141, v136
  v_mov_b32 v142, v136
  v_mov_b32 v143, v136
  v_mov_b32 v144, v136
  v_mov_b32 v145, v136
  v_mov_b32 v146, v136
  v_mov_b32 v147, v136
  v_mov_b32 v148, v136
  v_mov_b32 v149, v136
  v_mov_b32 v150, v136
  v_mov_b32 v151, v136
  buffer_load_dwordx4 v[116:119], v3, s[12:15], s33 offen offset:1024 sc1
  s_mov_b64 exec, s[20:21]
  buffer_load_dwordx4 v[136:139], v11, s[12:15], s36 offen sc1
  buffer_load_dwordx4 v[140:143], v11, s[12:15], s36 offen offset:512 sc1
  s_mov_b64 exec, -1
  v_add_u32 v12, s37, v3
  s_add_u32 s38, s37, 65536
  v_add_u32 v13, s38, v11
  s_cmp_eq_u32 s60, 0
  s_cbranch_scc0 concat_heads__ssm_conv_s4d__mha_block__prompt_kernel_safe
  buffer_load_dwordx4 v[120:123], v3, s[12:15], s33 offen offset:2048 sc1
  buffer_load_dwordx4 v[124:127], v3, s[12:15], s33 offen offset:3072 sc1
  buffer_load_dwordx4 v[132:135], v3, s[12:15], s34 offen offset:1024 sc1
  s_mov_b64 exec, s[20:21]
  buffer_load_dwordx4 v[144:147], v11, s[12:15], s36 offen offset:1024 sc1
  buffer_load_dwordx4 v[148:151], v11, s[12:15], s36 offen offset:1536 sc1
  s_mov_b64 exec, -1
  s_barrier
  v_mov_b32 v48, 0
  v_mov_b32 v49, 0
  v_mov_b32 v50, 0
  v_mov_b32 v51, 0
  v_mov_b32 v52, 0
  v_mov_b32 v53, 0
  v_mov_b32 v54, 0
  v_mov_b32 v55, 0
  v_mov_b32 v56, 0
  v_mov_b32 v57, 0
  v_mov_b32 v58, 0
  v_mov_b32 v59, 0
  v_mov_b32 v60, 0
  v_mov_b32 v61, 0
  v_mov_b32 v62, 0
  v_mov_b32 v63, 0
  v_mov_b32 v64, 0
  v_mov_b32 v65, 0
  v_mov_b32 v66, 0
  v_mov_b32 v67, 0
  v_mov_b32 v68, 0
  v_mov_b32 v69, 0
  v_mov_b32 v70, 0
  v_mov_b32 v71, 0
  v_mov_b32 v72, 0
  v_mov_b32 v73, 0
  v_mov_b32 v74, 0
  v_mov_b32 v75, 0
  v_mov_b32 v76, 0
  v_mov_b32 v77, 0
  v_mov_b32 v78, 0
  v_mov_b32 v79, 0
  v_mov_b32 v80, 0
  v_mov_b32 v81, 0
  v_mov_b32 v82, 0
  v_mov_b32 v83, 0
  v_mov_b32 v84, 0
  v_mov_b32 v85, 0
  v_mov_b32 v86, 0
  v_mov_b32 v87, 0
  v_mov_b32 v88, 0
  v_mov_b32 v89, 0
  v_mov_b32 v90, 0
  v_mov_b32 v91, 0
  v_mov_b32 v92, 0
  v_mov_b32 v93, 0
  v_mov_b32 v94, 0
  v_mov_b32 v95, 0
  v_mov_b32 v96, 0
  v_mov_b32 v97, 0
  v_mov_b32 v98, 0
  v_mov_b32 v99, 0
  v_mov_b32 v100, 0
  v_mov_b32 v101, 0
  v_mov_b32 v102, 0
  v_mov_b32 v103, 0
  v_mov_b32 v104, 0
  v_mov_b32 v105, 0
  v_mov_b32 v106, 0
  v_mov_b32 v107, 0
  v_mov_b32 v108, 0
  v_mov_b32 v109, 0
  v_mov_b32 v110, 0
  v_mov_b32 v111, 0
  s_cmp_ge_u32 s24, 4
  s_cbranch_scc0 concat_heads__ssm_conv_s4d__mha_block__prompt_kernel_np
  s_setprio 1
concat_heads__ssm_conv_s4d__mha_block__prompt_kernel_np:
  s_waitcnt vmcnt(8)
  v_mfma_f32_32x32x16_bf16 v[16:31], v[128:131], v[112:115], 0
  s_nop 7
  s_nop 3
  v_exp_f32 v16, v16
  v_exp_f32 v17, v17
  v_exp_f32 v18, v18
  v_exp_f32 v19, v19
  v_exp_f32 v20, v20
  v_exp_f32 v21, v21
  s_waitcnt vmcnt(7)
  v_mfma_f32_32x32x16_bf16 v[32:47], v[128:131], v[116:119], 0
  v_exp_f32 v22, v22
  v_exp_f32 v23, v23
  v_cvt_pk_bf16_f32 v16, v16, v17
  v_cvt_pk_bf16_f32 v17, v18, v19
  v_cvt_pk_bf16_f32 v18, v20, v21
  v_cvt_pk_bf16_f32 v19, v22, v23
  v_exp_f32 v24, v24
  v_exp_f32 v25, v25
  s_waitcnt vmcnt(5)
  v_mfma_f32_32x32x16_bf16 v[48:63], v[136:139], v[16:19], v[48:63]
  v_exp_f32 v26, v26
  v_exp_f32 v27, v27
  v_exp_f32 v28, v28
  v_exp_f32 v29, v29
  v_exp_f32 v30, v30
  v_exp_f32 v31, v31
  v_cvt_pk_bf16_f32 v20, v24, v25
  v_cvt_pk_bf16_f32 v21, v26, v27
  v_cvt_pk_bf16_f32 v22, v28, v29
  v_cvt_pk_bf16_f32 v23, v30, v31
  v_exp_f32 v32, v32
  v_exp_f32 v33, v33
  v_mfma_f32_32x32x16_bf16 v[48:63], v[140:143], v[20:23], v[48:63]
  v_exp_f32 v34, v34
  v_exp_f32 v35, v35
  v_exp_f32 v36, v36
  v_exp_f32 v37, v37
  s_waitcnt vmcnt(4)
  v_mfma_f32_32x32x16_bf16 v[16:31], v[128:131], v[120:123], 0
  v_exp_f32 v38, v38
  v_exp_f32 v39, v39
  v_cvt_pk_bf16_f32 v32, v32, v33
  v_cvt_pk_bf16_f32 v33, v34, v35
  v_cvt_pk_bf16_f32 v34, v36, v37
  v_cvt_pk_bf16_f32 v35, v38, v39
  v_exp_f32 v40, v40
  v_exp_f32 v41, v41
  v_mfma_f32_32x32x16_bf16 v[64:79], v[136:139], v[32:35], v[64:79]
  v_exp_f32 v42, v42
  v_exp_f32 v43, v43
  v_exp_f32 v44, v44
  v_exp_f32 v45, v45
  v_exp_f32 v46, v46
  v_exp_f32 v47, v47
  v_cvt_pk_bf16_f32 v36, v40, v41
  v_cvt_pk_bf16_f32 v37, v42, v43
  v_cvt_pk_bf16_f32 v38, v44, v45
  v_cvt_pk_bf16_f32 v39, v46, v47
  v_exp_f32 v16, v16
  v_exp_f32 v17, v17
  v_mfma_f32_32x32x16_bf16 v[64:79], v[140:143], v[36:39], v[64:79]
  v_exp_f32 v18, v18
  v_exp_f32 v19, v19
  v_exp_f32 v20, v20
  v_exp_f32 v21, v21
  s_waitcnt vmcnt(3)
  v_mfma_f32_32x32x16_bf16 v[32:47], v[128:131], v[124:127], 0
  v_exp_f32 v22, v22
  v_exp_f32 v23, v23
  v_cvt_pk_bf16_f32 v16, v16, v17
  v_cvt_pk_bf16_f32 v17, v18, v19
  v_cvt_pk_bf16_f32 v18, v20, v21
  v_cvt_pk_bf16_f32 v19, v22, v23
  v_exp_f32 v24, v24
  v_exp_f32 v25, v25
  v_mfma_f32_32x32x16_bf16 v[80:95], v[136:139], v[16:19], v[80:95]
  v_exp_f32 v26, v26
  v_exp_f32 v27, v27
  v_exp_f32 v28, v28
  v_exp_f32 v29, v29
  v_exp_f32 v30, v30
  v_exp_f32 v31, v31
  v_cvt_pk_bf16_f32 v20, v24, v25
  v_cvt_pk_bf16_f32 v21, v26, v27
  v_cvt_pk_bf16_f32 v22, v28, v29
  v_cvt_pk_bf16_f32 v23, v30, v31
  v_exp_f32 v32, v32
  v_exp_f32 v33, v33
  v_mfma_f32_32x32x16_bf16 v[80:95], v[140:143], v[20:23], v[80:95]
  v_exp_f32 v34, v34
  v_exp_f32 v35, v35
  v_exp_f32 v36, v36
  v_exp_f32 v37, v37
  s_waitcnt vmcnt(2)
  v_mfma_f32_32x32x16_bf16 v[16:31], v[132:135], v[112:115], 0
  v_exp_f32 v38, v38
  v_exp_f32 v39, v39
  v_cvt_pk_bf16_f32 v32, v32, v33
  v_cvt_pk_bf16_f32 v33, v34, v35
  v_cvt_pk_bf16_f32 v34, v36, v37
  v_cvt_pk_bf16_f32 v35, v38, v39
  v_exp_f32 v40, v40
  v_exp_f32 v41, v41
  v_mfma_f32_32x32x16_bf16 v[96:111], v[136:139], v[32:35], v[96:111]
  v_exp_f32 v42, v42
  v_exp_f32 v43, v43
  v_exp_f32 v44, v44
  v_exp_f32 v45, v45
  v_exp_f32 v46, v46
  v_exp_f32 v47, v47
  v_cvt_pk_bf16_f32 v36, v40, v41
  v_cvt_pk_bf16_f32 v37, v42, v43
  v_cvt_pk_bf16_f32 v38, v44, v45
  v_cvt_pk_bf16_f32 v39, v46, v47
  v_exp_f32 v16, v16
  v_exp_f32 v17, v17
  v_mfma_f32_32x32x16_bf16 v[96:111], v[140:143], v[36:39], v[96:111]
  v_exp_f32 v18, v18
  v_exp_f32 v19, v19
  v_exp_f32 v20, v20
  v_exp_f32 v21, v21
  v_mfma_f32_32x32x16_bf16 v[32:47], v[132:135], v[116:119], 0
  v_exp_f32 v22, v22
  v_exp_f32 v23, v23
  v_cvt_pk_bf16_f32 v16, v16, v17
  v_cvt_pk_bf16_f32 v17, v18, v19
  v_cvt_pk_bf16_f32 v18, v20, v21
  v_cvt_pk_bf16_f32 v19, v22, v23
  v_exp_f32 v24, v24
  v_exp_f32 v25, v25
  s_waitcnt vmcnt(0)
  v_mfma_f32_32x32x16_bf16 v[48:63], v[144:147], v[16:19], v[48:63]
  v_exp_f32 v26, v26
  v_exp_f32 v27, v27
  v_exp_f32 v28, v28
  v_exp_f32 v29, v29
  v_exp_f32 v30, v30
  v_exp_f32 v31, v31
  v_cvt_pk_bf16_f32 v20, v24, v25
  v_cvt_pk_bf16_f32 v21, v26, v27
  v_cvt_pk_bf16_f32 v22, v28, v29
  v_cvt_pk_bf16_f32 v23, v30, v31
  v_exp_f32 v32, v32
  v_exp_f32 v33, v33
  s_barrier
  v_mfma_f32_32x32x16_bf16 v[48:63], v[148:151], v[20:23], v[48:63]
  v_exp_f32 v34, v34
  v_exp_f32 v35, v35
  ds_read_b128 v[128:131], v12 offset:2048
  v_exp_f32 v36, v36
  v_exp_f32 v37, v37
  v_mfma_f32_32x32x16_bf16 v[16:31], v[132:135], v[120:123], 0
  v_exp_f32 v38, v38
  v_exp_f32 v39, v39
  v_cvt_pk_bf16_f32 v32, v32, v33
  v_cvt_pk_bf16_f32 v33, v34, v35
  v_cvt_pk_bf16_f32 v34, v36, v37
  v_cvt_pk_bf16_f32 v35, v38, v39
  v_exp_f32 v40, v40
  v_exp_f32 v41, v41
  v_mfma_f32_32x32x16_bf16 v[64:79], v[144:147], v[32:35], v[64:79]
  v_exp_f32 v42, v42
  s_mov_b64 exec, s[20:21]
  ds_read_b128 v[136:139], v13 offset:2048
  ds_read_b128 v[140:143], v13 offset:2560
  s_mov_b64 exec, -1
  v_exp_f32 v43, v43
  v_exp_f32 v44, v44
  v_exp_f32 v45, v45
  v_exp_f32 v46, v46
  v_exp_f32 v47, v47
  v_cvt_pk_bf16_f32 v36, v40, v41
  v_cvt_pk_bf16_f32 v37, v42, v43
  v_cvt_pk_bf16_f32 v38, v44, v45
  v_cvt_pk_bf16_f32 v39, v46, v47
  v_exp_f32 v16, v16
  v_exp_f32 v17, v17
  v_mfma_f32_32x32x16_bf16 v[64:79], v[148:151], v[36:39], v[64:79]
  v_exp_f32 v18, v18
  v_exp_f32 v19, v19
  v_exp_f32 v20, v20
  v_exp_f32 v21, v21
  v_mfma_f32_32x32x16_bf16 v[32:47], v[132:135], v[124:127], 0
  v_exp_f32 v22, v22
  v_exp_f32 v23, v23
  v_cvt_pk_bf16_f32 v16, v16, v17
  v_cvt_pk_bf16_f32 v17, v18, v19
  v_cvt_pk_bf16_f32 v18, v20, v21
  v_cvt_pk_bf16_f32 v19, v22, v23
  v_exp_f32 v24, v24
  v_exp_f32 v25, v25
  v_mfma_f32_32x32x16_bf16 v[80:95], v[144:147], v[16:19], v[80:95]
  v_exp_f32 v26, v26
  v_exp_f32 v27, v27
  v_exp_f32 v28, v28
  v_exp_f32 v29, v29
  v_exp_f32 v30, v30
  v_exp_f32 v31, v31
  v_cvt_pk_bf16_f32 v20, v24, v25
  v_cvt_pk_bf16_f32 v21, v26, v27
  v_cvt_pk_bf16_f32 v22, v28, v29
  v_cvt_pk_bf16_f32 v23, v30, v31
  v_exp_f32 v32, v32
  v_exp_f32 v33, v33
  v_mfma_f32_32x32x16_bf16 v[80:95], v[148:151], v[20:23], v[80:95]
  v_exp_f32 v34, v34
  v_exp_f32 v35, v35
  v_exp_f32 v36, v36
  v_exp_f32 v37, v37
  s_waitcnt lgkmcnt(2)
  v_mfma_f32_32x32x16_bf16 v[16:31], v[128:131], v[112:115], 0
  v_exp_f32 v38, v38
  v_exp_f32 v39, v39
  v_cvt_pk_bf16_f32 v32, v32, v33
  v_cvt_pk_bf16_f32 v33, v34, v35
  v_cvt_pk_bf16_f32 v34, v36, v37
  v_cvt_pk_bf16_f32 v35, v38, v39
  v_exp_f32 v40, v40
  v_exp_f32 v41, v41
  v_mfma_f32_32x32x16_bf16 v[96:111], v[144:147], v[32:35], v[96:111]
  v_exp_f32 v42, v42
  v_exp_f32 v43, v43
  v_exp_f32 v44, v44
  v_exp_f32 v45, v45
  v_exp_f32 v46, v46
  v_exp_f32 v47, v47
  v_cvt_pk_bf16_f32 v36, v40, v41
  v_cvt_pk_bf16_f32 v37, v42, v43
  v_cvt_pk_bf16_f32 v38, v44, v45
  v_cvt_pk_bf16_f32 v39, v46, v47
  v_add_u32 v12, 2048, v12
  v_add_u32 v13, 2048, v13
  s_mov_b32 s61, 0
concat_heads__ssm_conv_s4d__mha_block__prompt_kernel_loopf:
  v_exp_f32 v16, v16
  v_exp_f32 v17, v17
  v_mfma_f32_32x32x16_bf16 v[96:111], v[148:151], v[36:39], v[96:111]
  v_exp_f32 v18, v18
  v_exp_f32 v19, v19
  v_exp_f32 v20, v20
  v_exp_f32 v21, v21
  v_mfma_f32_32x32x16_bf16 v[32:47], v[128:131], v[116:119], 0
  v_exp_f32 v22, v22
  v_exp_f32 v23, v23
  v_cvt_pk_bf16_f32 v16, v16, v17
  v_cvt_pk_bf16_f32 v17, v18, v19
  v_cvt_pk_bf16_f32 v18, v20, v21
  v_cvt_pk_bf16_f32 v19, v22, v23
  v_exp_f32 v24, v24
  v_exp_f32 v25, v25
  s_waitcnt lgkmcnt(0)
  v_mfma_f32_32x32x16_bf16 v[48:63], v[136:139], v[16:19], v[48:63]
  v_exp_f32 v26, v26
  ds_read_b128 v[132:135], v12 offset:1024
  v_exp_f32 v27, v27
  v_exp_f32 v28, v28
  v_exp_f32 v29, v29
  v_exp_f32 v30, v30
  v_exp_f32 v31, v31
  v_cvt_pk_bf16_f32 v20, v24, v25
  v_cvt_pk_bf16_f32 v21, v26, v27
  v_cvt_pk_bf16_f32 v22, v28, v29
  v_cvt_pk_bf16_f32 v23, v30, v31
  v_exp_f32 v32, v32
  v_exp_f32 v33, v33
  v_mfma_f32_32x32x16_bf16 v[48:63], v[140:143], v[20:23], v[48:63]
  v_exp_f32 v34, v34
  v_exp_f32 v35, v35
  v_exp_f32 v36, v36
  v_exp_f32 v37, v37
  v_mfma_f32_32x32x16_bf16 v[16:31], v[128:131], v[120:123], 0
  v_exp_f32 v38, v38
  v_exp_f32 v39, v39
  v_cvt_pk_bf16_f32 v32, v32, v33
  v_cvt_pk_bf16_f32 v33, v34, v35
  v_cvt_pk_bf16_f32 v34, v36, v37
  v_cvt_pk_bf16_f32 v35, v38, v39
  v_exp_f32 v40, v40
  v_exp_f32 v41, v41
  v_mfma_f32_32x32x16_bf16 v[64:79], v[136:139], v[32:35], v[64:79]
  v_exp_f32 v42, v42
  s_mov_b64 exec, s[20:21]
  ds_read_b128 v[144:147], v13 offset:1024
  ds_read_b128 v[148:151], v13 offset:1536
  s_mov_b64 exec, -1
  v_exp_f32 v43, v43
  v_exp_f32 v44, v44
  v_exp_f32 v45, v45
  v_exp_f32 v46, v46
  v_exp_f32 v47, v47
  v_cvt_pk_bf16_f32 v36, v40, v41
  v_cvt_pk_bf16_f32 v37, v42, v43
  v_cvt_pk_bf16_f32 v38, v44, v45
  v_cvt_pk_bf16_f32 v39, v46, v47
  v_exp_f32 v16, v16
  v_exp_f32 v17, v17
  v_mfma_f32_32x32x16_bf16 v[64:79], v[140:143], v[36:39], v[64:79]
  v_exp_f32 v18, v18
  v_exp_f32 v19, v19
  v_exp_f32 v20, v20
  v_exp_f32 v21, v21
  v_mfma_f32_32x32x16_bf16 v[32:47], v[128:131], v[124:127], 0
  v_exp_f32 v22, v22
  v_exp_f32 v23, v23
  v_cvt_pk_bf16_f32 v16, v16, v17
  v_cvt_pk_bf16_f32 v17, v18, v19
  v_cvt_pk_bf16_f32 v18, v20, v21
  v_cvt_pk_bf16_f32 v19, v22, v23
  v_exp_f32 v24, v24
  v_exp_f32 v25, v25
  v_mfma_f32_32x32x16_bf16 v[80:95], v[136:139], v[16:19], v[80:95]
  v_exp_f32 v26, v26
  v_exp_f32 v27, v27
  v_exp_f32 v28, v28
  v_exp_f32 v29, v29
  v_exp_f32 v30, v30
  v_exp_f32 v31, v31
  v_cvt_pk_bf16_f32 v20, v24, v25
  v_cvt_pk_bf16_f32 v21, v26, v27
  v_cvt_pk_bf16_f32 v22, v28, v29
  v_cvt_pk_bf16_f32 v23, v30, v31
  v_exp_f32 v32, v32
  v_exp_f32 v33, v33
  v_mfma_f32_32x32x16_bf16 v[80:95], v[140:143], v[20:23], v[80:95]
  v_exp_f32 v34, v34
  v_exp_f32 v35, v35
  v_exp_f32 v36, v36
  v_exp_f32 v37, v37
  s_waitcnt lgkmcnt(2)
  v_mfma_f32_32x32x16_bf16 v[16:31], v[132:135], v[112:115], 0
  v_exp_f32 v38, v38
  v_exp_f32 v39, v39
  v_cvt_pk_bf16_f32 v32, v32, v33
  v_cvt_pk_bf16_f32 v33, v34, v35
  v_cvt_pk_bf16_f32 v34, v36, v37
  v_cvt_pk_bf16_f32 v35, v38, v39
  v_exp_f32 v40, v40
  v_exp_f32 v41, v41
  v_mfma_f32_32x32x16_bf16 v[96:111], v[136:139], v[32:35], v[96:111]
  v_exp_f32 v42, v42
  v_exp_f32 v43, v43
  v_exp_f32 v44, v44
  v_exp_f32 v45, v45
  v_exp_f32 v46, v46
  v_exp_f32 v47, v47
  v_cvt_pk_bf16_f32 v36, v40, v41
  v_cvt_pk_bf16_f32 v37, v42, v43
  v_cvt_pk_bf16_f32 v38, v44, v45
  v_cvt_pk_bf16_f32 v39, v46, v47
  v_exp_f32 v16, v16
  v_exp_f32 v17, v17
  v_mfma_f32_32x32x16_bf16 v[96:111], v[140:143], v[36:39], v[96:111]
  v_exp_f32 v18, v18
  v_exp_f32 v19, v19
  v_exp_f32 v20, v20
  v_exp_f32 v21, v21
  v_mfma_f32_32x32x16_bf16 v[32:47], v[132:135], v[116:119], 0
  v_exp_f32 v22, v22
  v_exp_f32 v23, v23
  v_cvt_pk_bf16_f32 v16, v16, v17
  v_cvt_pk_bf16_f32 v17, v18, v19
  v_cvt_pk_bf16_f32 v18, v20, v21
  v_cvt_pk_bf16_f32 v19, v22, v23
  v_exp_f32 v24, v24
  v_exp_f32 v25, v25
  s_waitcnt lgkmcnt(0)
  v_mfma_f32_32x32x16_bf16 v[48:63], v[144:147], v[16:19], v[48:63]
  v_exp_f32 v26, v26
  ds_read_b128 v[128:131], v12 offset:2048
  v_exp_f32 v27, v27
  v_exp_f32 v28, v28
  v_exp_f32 v29, v29
  v_exp_f32 v30, v30
  v_exp_f32 v31, v31
  v_cvt_pk_bf16_f32 v20, v24, v25
  v_cvt_pk_bf16_f32 v21, v26, v27
  v_cvt_pk_bf16_f32 v22, v28, v29
  v_cvt_pk_bf16_f32 v23, v30, v31
  v_exp_f32 v32, v32
  v_exp_f32 v33, v33
  v_mfma_f32_32x32x16_bf16 v[48:63], v[148:151], v[20:23], v[48:63]
  v_exp_f32 v34, v34
  v_exp_f32 v35, v35
  v_exp_f32 v36, v36
  v_exp_f32 v37, v37
  v_mfma_f32_32x32x16_bf16 v[16:31], v[132:135], v[120:123], 0
  v_exp_f32 v38, v38
  v_exp_f32 v39, v39
  v_cvt_pk_bf16_f32 v32, v32, v33
  v_cvt_pk_bf16_f32 v33, v34, v35
  v_cvt_pk_bf16_f32 v34, v36, v37
  v_cvt_pk_bf16_f32 v35, v38, v39
  v_exp_f32 v40, v40
  v_exp_f32 v41, v41
  v_mfma_f32_32x32x16_bf16 v[64:79], v[144:147], v[32:35], v[64:79]
  v_exp_f32 v42, v42
  s_mov_b64 exec, s[20:21]
  ds_read_b128 v[136:139], v13 offset:2048
  ds_read_b128 v[140:143], v13 offset:2560
  s_mov_b64 exec, -1
  v_exp_f32 v43, v43
  v_exp_f32 v44, v44
  v_exp_f32 v45, v45
  v_exp_f32 v46, v46
  v_exp_f32 v47, v47
  v_cvt_pk_bf16_f32 v36, v40, v41
  v_cvt_pk_bf16_f32 v37, v42, v43
  v_cvt_pk_bf16_f32 v38, v44, v45
  v_cvt_pk_bf16_f32 v39, v46, v47
  v_exp_f32 v16, v16
  v_exp_f32 v17, v17
  v_mfma_f32_32x32x16_bf16 v[64:79], v[148:151], v[36:39], v[64:79]
  v_exp_f32 v18, v18
  v_exp_f32 v19, v19
  v_exp_f32 v20, v20
  v_exp_f32 v21, v21
  v_mfma_f32_32x32x16_bf16 v[32:47], v[132:135], v[124:127], 0
  v_exp_f32 v22, v22
  v_exp_f32 v23, v23
  v_cvt_pk_bf16_f32 v16, v16, v17
  v_cvt_pk_bf16_f32 v17, v18, v19
  v_cvt_pk_bf16_f32 v18, v20, v21
  v_cvt_pk_bf16_f32 v19, v22, v23
  v_exp_f32 v24, v24
  v_exp_f32 v25, v25
  v_mfma_f32_32x32x16_bf16 v[80:95], v[144:147], v[16:19], v[80:95]
  v_exp_f32 v26, v26
  v_exp_f32 v27, v27
  v_exp_f32 v28, v28
  v_exp_f32 v29, v29
  v_exp_f32 v30, v30
  v_exp_f32 v31, v31
  v_cvt_pk_bf16_f32 v20, v24, v25
  v_cvt_pk_bf16_f32 v21, v26, v27
  v_cvt_pk_bf16_f32 v22, v28, v29
  v_cvt_pk_bf16_f32 v23, v30, v31
  v_exp_f32 v32, v32
  v_exp_f32 v33, v33
  v_mfma_f32_32x32x16_bf16 v[80:95], v[148:151], v[20:23], v[80:95]
  v_exp_f32 v34, v34
  v_exp_f32 v35, v35
  v_exp_f32 v36, v36
  v_exp_f32 v37, v37
  s_waitcnt lgkmcnt(2)
  v_mfma_f32_32x32x16_bf16 v[16:31], v[128:131], v[112:115], 0
  v_exp_f32 v38, v38
  v_exp_f32 v39, v39
  v_cvt_pk_bf16_f32 v32, v32, v33
  v_cvt_pk_bf16_f32 v33, v34, v35
  v_cvt_pk_bf16_f32 v34, v36, v37
  v_cvt_pk_bf16_f32 v35, v38, v39
  v_exp_f32 v40, v40
  v_exp_f32 v41, v41
  v_mfma_f32_32x32x16_bf16 v[96:111], v[144:147], v[32:35], v[96:111]
  v_exp_f32 v42, v42
  v_exp_f32 v43, v43
  v_exp_f32 v44, v44
  v_exp_f32 v45, v45
  v_exp_f32 v46, v46
  v_exp_f32 v47, v47
  v_cvt_pk_bf16_f32 v36, v40, v41
  v_cvt_pk_bf16_f32 v37, v42, v43
  v_cvt_pk_bf16_f32 v38, v44, v45
  v_cvt_pk_bf16_f32 v39, v46, v47
  v_add_u32 v12, 2048, v12
  v_add_u32 v13, 2048, v13
  s_add_u32 s61, s61, 1
  s_cmp_eq_u32 s61, 6
  s_cbranch_scc0 concat_heads__ssm_conv_s4d__mha_block__prompt_kernel_np2
  s_setprio 0
concat_heads__ssm_conv_s4d__mha_block__prompt_kernel_np2:
  s_cmp_lt_u32 s61, 6
  s_cbranch_scc1 concat_heads__ssm_conv_s4d__mha_block__prompt_kernel_loopf
  v_exp_f32 v16, v16
  v_exp_f32 v17, v17
  v_mfma_f32_32x32x16_bf16 v[96:111], v[148:151], v[36:39], v[96:111]
  v_exp_f32 v18, v18
  v_exp_f32 v19, v19
  v_exp_f32 v20, v20
  v_exp_f32 v21, v21
  v_mfma_f32_32x32x16_bf16 v[32:47], v[128:131], v[116:119], 0
  v_exp_f32 v22, v22
  v_exp_f32 v23, v23
  v_cvt_pk_bf16_f32 v16, v16, v17
  v_cvt_pk_bf16_f32 v17, v18, v19
  v_cvt_pk_bf16_f32 v18, v20, v21
  v_cvt_pk_bf16_f32 v19, v22, v23
  v_exp_f32 v24, v24
  v_exp_f32 v25, v25
  s_waitcnt lgkmcnt(0)
  v_mfma_f32_32x32x16_bf16 v[48:63], v[136:139], v[16:19], v[48:63]
  v_exp_f32 v26, v26
  ds_read_b128 v[132:135], v12 offset:1024
  v_exp_f32 v27, v27
  v_exp_f32 v28, v28
  v_exp_f32 v29, v29
  v_exp_f32 v30, v30
  v_exp_f32 v31, v31
  v_cvt_pk_bf16_f32 v20, v24, v25
  v_cvt_pk_bf16_f32 v21, v26, v27
  v_cvt_pk_bf16_f32 v22, v28, v29
  v_cvt_pk_bf16_f32 v23, v30, v31
  v_exp_f32 v32, v32
  v_exp_f32 v33, v33
  v_mfma_f32_32x32x16_bf16 v[48:63], v[140:143], v[20:23], v[48:63]
  v_exp_f32 v34, v34
  v_exp_f32 v35, v35
  v_exp_f32 v36, v36
  v_exp_f32 v37, v37
  v_mfma_f32_32x32x16_bf16 v[16:31], v[128:131], v[120:123], 0
  v_exp_f32 v38, v38
  v_exp_f32 v39, v39
  v_cvt_pk_bf16_f32 v32, v32, v33
  v_cvt_pk_bf16_f32 v33, v34, v35
  v_cvt_pk_bf16_f32 v34, v36, v37
  v_cvt_pk_bf16_f32 v35, v38, v39
  v_exp_f32 v40, v40
  v_exp_f32 v41, v41
  v_mfma_f32_32x32x16_bf16 v[64:79], v[136:139], v[32:35], v[64:79]
  v_exp_f32 v42, v42
  s_mov_b64 exec, s[20:21]
  ds_read_b128 v[144:147], v13 offset:1024
  ds_read_b128 v[148:151], v13 offset:1536
  s_mov_b64 exec, -1
  v_exp_f32 v43, v43
  v_exp_f32 v44, v44
  v_exp_f32 v45, v45
  v_exp_f32 v46, v46
  v_exp_f32 v47, v47
  v_cvt_pk_bf16_f32 v36, v40, v41
  v_cvt_pk_bf16_f32 v37, v42, v43
  v_cvt_pk_bf16_f32 v38, v44, v45
  v_cvt_pk_bf16_f32 v39, v46, v47
  v_exp_f32 v16, v16
  v_exp_f32 v17, v17
  v_mfma_f32_32x32x16_bf16 v[64:79], v[140:143], v[36:39], v[64:79]
  v_exp_f32 v18, v18
  v_exp_f32 v19, v19
  v_exp_f32 v20, v20
  v_exp_f32 v21, v21
  v_mfma_f32_32x32x16_bf16 v[32:47], v[128:131], v[124:127], 0
  v_exp_f32 v22, v22
  v_exp_f32 v23, v23
  v_cvt_pk_bf16_f32 v16, v16, v17
  v_cvt_pk_bf16_f32 v17, v18, v19
  v_cvt_pk_bf16_f32 v18, v20, v21
  v_cvt_pk_bf16_f32 v19, v22, v23
  v_exp_f32 v24, v24
  v_exp_f32 v25, v25
  v_mfma_f32_32x32x16_bf16 v[80:95], v[136:139], v[16:19], v[80:95]
  v_exp_f32 v26, v26
  v_exp_f32 v27, v27
  v_exp_f32 v28, v28
  v_exp_f32 v29, v29
  v_exp_f32 v30, v30
  v_exp_f32 v31, v31
  v_cvt_pk_bf16_f32 v20, v24, v25
  v_cvt_pk_bf16_f32 v21, v26, v27
  v_cvt_pk_bf16_f32 v22, v28, v29
  v_cvt_pk_bf16_f32 v23, v30, v31
  v_exp_f32 v32, v32
  v_exp_f32 v33, v33
  v_mfma_f32_32x32x16_bf16 v[80:95], v[140:143], v[20:23], v[80:95]
  v_exp_f32 v34, v34
  v_exp_f32 v35, v35
  v_exp_f32 v36, v36
  v_exp_f32 v37, v37
  s_waitcnt lgkmcnt(2)
  v_mfma_f32_32x32x16_bf16 v[16:31], v[132:135], v[112:115], 0
  v_exp_f32 v38, v38
  v_exp_f32 v39, v39
  v_cvt_pk_bf16_f32 v32, v32, v33
  v_cvt_pk_bf16_f32 v33, v34, v35
  v_cvt_pk_bf16_f32 v34, v36, v37
  v_cvt_pk_bf16_f32 v35, v38, v39
  v_exp_f32 v40, v40
  v_exp_f32 v41, v41
  v_mfma_f32_32x32x16_bf16 v[96:111], v[136:139], v[32:35], v[96:111]
  v_exp_f32 v42, v42
  v_exp_f32 v43, v43
  v_exp_f32 v44, v44
  v_exp_f32 v45, v45
  v_exp_f32 v46, v46
  v_exp_f32 v47, v47
  v_cvt_pk_bf16_f32 v36, v40, v41
  v_cvt_pk_bf16_f32 v37, v42, v43
  v_cvt_pk_bf16_f32 v38, v44, v45
  v_cvt_pk_bf16_f32 v39, v46, v47
  v_exp_f32 v16, v16
  v_exp_f32 v17, v17
  v_mfma_f32_32x32x16_bf16 v[96:111], v[140:143], v[36:39], v[96:111]
  v_exp_f32 v18, v18
  v_exp_f32 v19, v19
  v_exp_f32 v20, v20
  v_exp_f32 v21, v21
  v_mfma_f32_32x32x16_bf16 v[32:47], v[132:135], v[116:119], 0
  v_exp_f32 v22, v22
  v_exp_f32 v23, v23
  v_cvt_pk_bf16_f32 v16, v16, v17
  v_cvt_pk_bf16_f32 v17, v18, v19
  v_cvt_pk_bf16_f32 v18, v20, v21
  v_cvt_pk_bf16_f32 v19, v22, v23
  v_exp_f32 v24, v24
  v_exp_f32 v25, v25
  s_waitcnt lgkmcnt(0)
  v_mfma_f32_32x32x16_bf16 v[48:63], v[144:147], v[16:19], v[48:63]
  v_exp_f32 v26, v26
  v_exp_f32 v27, v27
  v_exp_f32 v28, v28
  v_exp_f32 v29, v29
  v_exp_f32 v30, v30
  v_exp_f32 v31, v31
  v_cvt_pk_bf16_f32 v20, v24, v25
  v_cvt_pk_bf16_f32 v21, v26, v27
  v_cvt_pk_bf16_f32 v22, v28, v29
  v_cvt_pk_bf16_f32 v23, v30, v31
  v_exp_f32 v32, v32
  v_exp_f32 v33, v33
  v_mfma_f32_32x32x16_bf16 v[48:63], v[148:151], v[20:23], v[48:63]
  v_exp_f32 v34, v34
  v_exp_f32 v35, v35
  v_exp_f32 v36, v36
  v_exp_f32 v37, v37
  v_mfma_f32_32x32x16_bf16 v[16:31], v[132:135], v[120:123], 0
  v_exp_f32 v38, v38
  v_exp_f32 v39, v39
  v_cvt_pk_bf16_f32 v32, v32, v33
  v_cvt_pk_bf16_f32 v33, v34, v35
  v_cvt_pk_bf16_f32 v34, v36, v37
  v_cvt_pk_bf16_f32 v35, v38, v39
  v_exp_f32 v40, v40
  v_exp_f32 v41, v41
  v_mfma_f32_32x32x16_bf16 v[64:79], v[144:147], v[32:35], v[64:79]
  v_exp_f32 v42, v42
  v_exp_f32 v43, v43
  v_exp_f32 v44, v44
  v_exp_f32 v45, v45
  v_exp_f32 v46, v46
  v_exp_f32 v47, v47
  v_cvt_pk_bf16_f32 v36, v40, v41
  v_cvt_pk_bf16_f32 v37, v42, v43
  v_cvt_pk_bf16_f32 v38, v44, v45
  v_cvt_pk_bf16_f32 v39, v46, v47
  v_exp_f32 v16, v16
  v_exp_f32 v17, v17
  v_mfma_f32_32x32x16_bf16 v[64:79], v[148:151], v[36:39], v[64:79]
  v_exp_f32 v18, v18
  v_exp_f32 v19, v19
  v_exp_f32 v20, v20
  v_exp_f32 v21, v21
  v_mfma_f32_32x32x16_bf16 v[32:47], v[132:135], v[124:127], 0
  v_exp_f32 v22, v22
  v_exp_f32 v23, v23
  v_cvt_pk_bf16_f32 v16, v16, v17
  v_cvt_pk_bf16_f32 v17, v18, v19
  v_cvt_pk_bf16_f32 v18, v20, v21
  v_cvt_pk_bf16_f32 v19, v22, v23
  v_exp_f32 v24, v24
  v_exp_f32 v25, v25
  v_mfma_f32_32x32x16_bf16 v[80:95], v[144:147], v[16:19], v[80:95]
  v_exp_f32 v26, v26
  v_exp_f32 v27, v27
  v_exp_f32 v28, v28
  v_exp_f32 v29, v29
  v_exp_f32 v30, v30
  v_exp_f32 v31, v31
  v_cvt_pk_bf16_f32 v20, v24, v25
  v_cvt_pk_bf16_f32 v21, v26, v27
  v_cvt_pk_bf16_f32 v22, v28, v29
  v_cvt_pk_bf16_f32 v23, v30, v31
  v_exp_f32 v32, v32
  v_exp_f32 v33, v33
  v_mfma_f32_32x32x16_bf16 v[80:95], v[148:151], v[20:23], v[80:95]
  v_exp_f32 v34, v34
  v_exp_f32 v35, v35
  v_exp_f32 v36, v36
  v_exp_f32 v37, v37
  v_exp_f32 v38, v38
  v_exp_f32 v39, v39
  v_cvt_pk_bf16_f32 v32, v32, v33
  v_cvt_pk_bf16_f32 v33, v34, v35
  v_cvt_pk_bf16_f32 v34, v36, v37
  v_cvt_pk_bf16_f32 v35, v38, v39
  v_exp_f32 v40, v40
  v_exp_f32 v41, v41
  v_mfma_f32_32x32x16_bf16 v[96:111], v[144:147], v[32:35], v[96:111]
  v_exp_f32 v42, v42
  v_exp_f32 v43, v43
  v_exp_f32 v44, v44
  v_exp_f32 v45, v45
  v_exp_f32 v46, v46
  v_exp_f32 v47, v47
  v_cvt_pk_bf16_f32 v36, v40, v41
  v_cvt_pk_bf16_f32 v37, v42, v43
  v_cvt_pk_bf16_f32 v38, v44, v45
  v_cvt_pk_bf16_f32 v39, v46, v47
  s_nop 1
  v_mfma_f32_32x32x16_bf16 v[96:111], v[148:151], v[36:39], v[96:111]
  s_setprio 0
  s_branch concat_heads__ssm_conv_s4d__mha_block__prompt_kernel_epi
concat_heads__ssm_conv_s4d__mha_block__prompt_kernel_safe:
  s_barrier
  buffer_load_dwordx4 v[120:123], v3, s[12:15], s33 offen offset:2048 sc1
  buffer_load_dwordx4 v[124:127], v3, s[12:15], s33 offen offset:3072 sc1
  s_waitcnt vmcnt(0)
  s_barrier
  v_mov_b32 v152, 0xff800000
  v_mov_b32 v153, 0xff800000
  v_mov_b32 v154, 0xff800000
  v_mov_b32 v155, 0xff800000
  s_mov_b32 s61, 0
  v_mov_b32 v156, v12
concat_heads__ssm_conv_s4d__mha_block__prompt_kernel_mxloop:
  ds_read_b128 v[32:35], v156
  s_waitcnt lgkmcnt(0)
  v_mfma_f32_32x32x16_bf16 v[16:31], v[32:35], v[112:115], 0
  s_nop 7
  s_nop 7
  v_max3_f32 v152, v16, v17, v152
  v_max3_f32 v152, v18, v19, v152
  v_max3_f32 v152, v20, v21, v152
  v_max3_f32 v152, v22, v23, v152
  v_max3_f32 v152, v24, v25, v152
  v_max3_f32 v152, v26, v27, v152
  v_max3_f32 v152, v28, v29, v152
  v_max3_f32 v152, v30, v31, v152
  v_mfma_f32_32x32x16_bf16 v[16:31], v[32:35], v[116:119], 0
  s_nop 7
  s_nop 7
  v_max3_f32 v153, v16, v17, v153
  v_max3_f32 v153, v18, v19, v153
  v_max3_f32 v153, v20, v21, v153
  v_max3_f32 v153, v22, v23, v153
  v_max3_f32 v153, v24, v25, v153
  v_max3_f32 v153, v26, v27, v153
  v_max3_f32 v153, v28, v29, v153
  v_max3_f32 v153, v30, v31, v153
  v_mfma_f32_32x32x16_bf16 v[16:31], v[32:35], v[120:123], 0
  s_nop 7
  s_nop 7
  v_max3_f32 v154, v16, v17, v154
  v_max3_f32 v154, v18, v19, v154
  v_max3_f32 v154, v20, v21, v154
  v_max3_f32 v154, v22, v23, v154
  v_max3_f32 v154, v24, v25, v154
  v_max3_f32 v154, v26, v27, v154
  v_max3_f32 v154, v28, v29, v154
  v_max3_f32 v154, v30, v31, v154
  v_mfma_f32_32x32x16_bf16 v[16:31], v[32:35], v[124:127], 0
  s_nop 7
  s_nop 7
  v_max3_f32 v155, v16, v17, v155
  v_max3_f32 v155, v18, v19, v155
  v_max3_f32 v155, v20, v21, v155
  v_max3_f32 v155, v22, v23, v155
  v_max3_f32 v155, v24, v25, v155
  v_max3_f32 v155, v26, v27, v155
  v_max3_f32 v155, v28, v29, v155
  v_max3_f32 v155, v30, v31, v155
  v_add_u32 v156, 1024, v156
  s_add_u32 s61, s61, 1
  s_cmp_lt_u32 s61, 16
  s_cbranch_scc1 concat_heads__ssm_conv_s4d__mha_block__prompt_kernel_mxloop
  s_lshl_b32 s62, s24, 10
  s_add_u32 s62, s62, 152064
  v_lshlrev_b32 v156, 2, v2
  v_add_u32 v156, s62, v156
  ds_write_b32 v156, v152 offset:0
  ds_write_b32 v156, v153 offset:256
  ds_write_b32 v156, v154 offset:512
  ds_write_b32 v156, v155 offset:768
  s_waitcnt lgkmcnt(0)
  s_barrier
  s_lshl_b32 s62, s28, 10
  s_add_u32 s62, s62, 152064
  v_and_b32 v156, 31, v2
  v_lshlrev_b32 v156, 2, v156
  v_add_u32 v156, s62, v156
  ds_read_b32 v16, v156 offset:0
  ds_read_b32 v17, v156 offset:128
  ds_read_b32 v18, v156 offset:2048
  ds_read_b32 v19, v156 offset:2176
  ds_read_b32 v20, v156 offset:4096
  ds_read_b32 v21, v156 offset:4224
  ds_read_b32 v22, v156 offset:6144
  ds_read_b32 v23, v156 offset:6272
  s_waitcnt lgkmcnt(0)
  v_max3_f32 v152, v16, v17, v18
  v_max3_f32 v152, v19, v20, v152
  v_max3_f32 v152, v21, v22, v152
  v_max_f32 v152, v23, v152
  v_sub_f32 v152, 0, v152
  ds_read_b32 v16, v156 offset:256
  ds_read_b32 v17, v156 offset:384
  ds_read_b32 v18, v156 offset:2304
  ds_read_b32 v19, v156 offset:2432
  ds_read_b32 v20, v156 offset:4352
  ds_read_b32 v21, v156 offset:4480
  ds_read_b32 v22, v156 offset:6400
  ds_read_b32 v23, v156 offset:6528
  s_waitcnt lgkmcnt(0)
  v_max3_f32 v153, v16, v17, v18
  v_max3_f32 v153, v19, v20, v153
  v_max3_f32 v153, v21, v22, v153
  v_max_f32 v153, v23, v153
  v_sub_f32 v153, 0, v153
  ds_read_b32 v16, v156 offset:512
  ds_read_b32 v17, v156 offset:640
  ds_read_b32 v18, v156 offset:2560
  ds_read_b32 v19, v156 offset:2688
  ds_read_b32 v20, v156 offset:4608
  ds_read_b32 v21, v156 offset:4736
  ds_read_b32 v22, v156 offset:6656
  ds_read_b32 v23, v156 offset:6784
  s_waitcnt lgkmcnt(0)
  v_max3_f32 v154, v16, v17, v18
  v_max3_f32 v154, v19, v20, v154
  v_max3_f32 v154, v21, v22, v154
  v_max_f32 v154, v23, v154
  v_sub_f32 v154, 0, v154
  ds_read_b32 v16, v156 offset:768
  ds_read_b32 v17, v156 offset:896
  ds_read_b32 v18, v156 offset:2816
  ds_read_b32 v19, v156 offset:2944
  ds_read_b32 v20, v156 offset:4864
  ds_read_b32 v21, v156 offset:4992
  ds_read_b32 v22, v156 offset:6912
  ds_read_b32 v23, v156 offset:7040
  s_waitcnt lgkmcnt(0)
  v_max3_f32 v155, v16, v17, v18
  v_max3_f32 v155, v19, v20, v155
  v_max3_f32 v155, v21, v22, v155
  v_max_f32 v155, v23, v155
  v_sub_f32 v155, 0, v155
  buffer_load_dwordx4 v[120:123], v3, s[12:15], s33 offen offset:2048 sc1
  buffer_load_dwordx4 v[124:127], v3, s[12:15], s33 offen offset:3072 sc1
  buffer_load_dwordx4 v[132:135], v3, s[12:15], s34 offen offset:1024 sc1
  s_mov_b64 exec, s[20:21]
  buffer_load_dwordx4 v[144:147], v11, s[12:15], s36 offen offset:1024 sc1
  buffer_load_dwordx4 v[148:151], v11, s[12:15], s36 offen offset:1536 sc1
  s_mov_b64 exec, -1
  s_barrier
  v_mov_b32 v48, 0
  v_mov_b32 v49, 0
  v_mov_b32 v50, 0
  v_mov_b32 v51, 0
  v_mov_b32 v52, 0
  v_mov_b32 v53, 0
  v_mov_b32 v54, 0
  v_mov_b32 v55, 0
  v_mov_b32 v56, 0
  v_mov_b32 v57, 0
  v_mov_b32 v58, 0
  v_mov_b32 v59, 0
  v_mov_b32 v60, 0
  v_mov_b32 v61, 0
  v_mov_b32 v62, 0
  v_mov_b32 v63, 0
  v_mov_b32 v64, 0
  v_mov_b32 v65, 0
  v_mov_b32 v66, 0
  v_mov_b32 v67, 0
  v_mov_b32 v68, 0
  v_mov_b32 v69, 0
  v_mov_b32 v70, 0
  v_mov_b32 v71, 0
  v_mov_b32 v72, 0
  v_mov_b32 v73, 0
  v_mov_b32 v74, 0
  v_mov_b32 v75, 0
  v_mov_b32 v76, 0
  v_mov_b32 v77, 0
  v_mov_b32 v78, 0
  v_mov_b32 v79, 0
  v_mov_b32 v80, 0
  v_mov_b32 v81, 0
  v_mov_b32 v82, 0
  v_mov_b32 v83, 0
  v_mov_b32 v84, 0
  v_mov_b32 v85, 0
  v_mov_b32 v86, 0
  v_mov_b32 v87, 0
  v_mov_b32 v88, 0
  v_mov_b32 v89, 0
  v_mov_b32 v90, 0
  v_mov_b32 v91, 0
  v_mov_b32 v92, 0
  v_mov_b32 v93, 0
  v_mov_b32 v94, 0
  v_mov_b32 v95, 0
  v_mov_b32 v96, 0
  v_mov_b32 v97, 0
  v_mov_b32 v98, 0
  v_mov_b32 v99, 0
  v_mov_b32 v100, 0
  v_mov_b32 v101, 0
  v_mov_b32 v102, 0
  v_mov_b32 v103, 0
  v_mov_b32 v104, 0
  v_mov_b32 v105, 0
  v_mov_b32 v106, 0
  v_mov_b32 v107, 0
  v_mov_b32 v108, 0
  v_mov_b32 v109, 0
  v_mov_b32 v110, 0
  v_mov_b32 v111, 0
  s_waitcnt vmcnt(8)
  v_mfma_f32_32x32x16_bf16 v[16:31], v[128:131], v[112:115], 0
  s_nop 7
  s_nop 3
  v_add_f32 v16, v152, v16
  v_exp_f32 v16, v16
  v_add_f32 v17, v152, v17
  v_exp_f32 v17, v17
  v_add_f32 v18, v152, v18
  v_exp_f32 v18, v18
  v_add_f32 v19, v152, v19
  v_exp_f32 v19, v19
  v_add_f32 v20, v152, v20
  v_exp_f32 v20, v20
  v_add_f32 v21, v152, v21
  v_exp_f32 v21, v21
  s_waitcnt vmcnt(7)
  v_mfma_f32_32x32x16_bf16 v[32:47], v[128:131], v[116:119], 0
  v_add_f32 v22, v152, v22
  v_exp_f32 v22, v22
  v_add_f32 v23, v152, v23
  v_exp_f32 v23, v23
  v_cvt_pk_bf16_f32 v16, v16, v17
  v_cvt_pk_bf16_f32 v17, v18, v19
  v_cvt_pk_bf16_f32 v18, v20, v21
  v_cvt_pk_bf16_f32 v19, v22, v23
  v_add_f32 v24, v152, v24
  v_exp_f32 v24, v24
  v_add_f32 v25, v152, v25
  v_exp_f32 v25, v25
  s_waitcnt vmcnt(5)
  v_mfma_f32_32x32x16_bf16 v[48:63], v[136:139], v[16:19], v[48:63]
  v_add_f32 v26, v152, v26
  v_exp_f32 v26, v26
  v_add_f32 v27, v152, v27
  v_exp_f32 v27, v27
  v_add_f32 v28, v152, v28
  v_exp_f32 v28, v28
  v_add_f32 v29, v152, v29
  v_exp_f32 v29, v29
  v_add_f32 v30, v152, v30
  v_exp_f32 v30, v30
  v_add_f32 v31, v152, v31
  v_exp_f32 v31, v31
  v_cvt_pk_bf16_f32 v20, v24, v25
  v_cvt_pk_bf16_f32 v21, v26, v27
  v_cvt_pk_bf16_f32 v22, v28, v29
  v_cvt_pk_bf16_f32 v23, v30, v31
  v_add_f32 v32, v153, v32
  v_exp_f32 v32, v32
  v_add_f32 v33, v153, v33
  v_exp_f32 v33, v33
  v_mfma_f32_32x32x16_bf16 v[48:63], v[140:143], v[20:23], v[48:63]
  v_add_f32 v34, v153, v34
  v_exp_f32 v34, v34
  v_add_f32 v35, v153, v35
  v_exp_f32 v35, v35
  v_add_f32 v36, v153, v36
  v_exp_f32 v36, v36
  v_add_f32 v37, v153, v37
  v_exp_f32 v37, v37
  s_waitcnt vmcnt(4)
  v_mfma_f32_32x32x16_bf16 v[16:31], v[128:131], v[120:123], 0
  v_add_f32 v38, v153, v38
  v_exp_f32 v38, v38
  v_add_f32 v39, v153, v39
  v_exp_f32 v39, v39
  v_cvt_pk_bf16_f32 v32, v32, v33
  v_cvt_pk_bf16_f32 v33, v34, v35
  v_cvt_pk_bf16_f32 v34, v36, v37
  v_cvt_pk_bf16_f32 v35, v38, v39
  v_add_f32 v40, v153, v40
  v_exp_f32 v40, v40
  v_add_f32 v41, v153, v41
  v_exp_f32 v41, v41
  v_mfma_f32_32x32x16_bf16 v[64:79], v[136:139], v[32:35], v[64:79]
  v_add_f32 v42, v153, v42
  v_exp_f32 v42, v42
  v_add_f32 v43, v153, v43
  v_exp_f32 v43, v43
  v_add_f32 v44, v153, v44
  v_exp_f32 v44, v44
  v_add_f32 v45, v153, v45
  v_exp_f32 v45, v45
  v_add_f32 v46, v153, v46
  v_exp_f32 v46, v46
  v_add_f32 v47, v153, v47
  v_exp_f32 v47, v47
  v_cvt_pk_bf16_f32 v36, v40, v41
  v_cvt_pk_bf16_f32 v37, v42, v43
  v_cvt_pk_bf16_f32 v38, v44, v45
  v_cvt_pk_bf16_f32 v39, v46, v47
  v_add_f32 v16, v154, v16
  v_exp_f32 v16, v16
  v_add_f32 v17, v154, v17
  v_exp_f32 v17, v17
  v_mfma_f32_32x32x16_bf16 v[64:79], v[140:143], v[36:39], v[64:79]
  v_add_f32 v18, v154, v18
  v_exp_f32 v18, v18
  v_add_f32 v19, v154, v19
  v_exp_f32 v19, v19
  v_add_f32 v20, v154, v20
  v_exp_f32 v20, v20
  v_add_f32 v21, v154, v21
  v_exp_f32 v21, v21
  s_waitcnt vmcnt(3)
  v_mfma_f32_32x32x16_bf16 v[32:47], v[128:131], v[124:127], 0
  v_add_f32 v22, v154, v22
  v_exp_f32 v22, v22
  v_add_f32 v23, v154, v23
  v_exp_f32 v23, v23
  v_cvt_pk_bf16_f32 v16, v16, v17
  v_cvt_pk_bf16_f32 v17, v18, v19
  v_cvt_pk_bf16_f32 v18, v20, v21
  v_cvt_pk_bf16_f32 v19, v22, v23
  v_add_f32 v24, v154, v24
  v_exp_f32 v24, v24
  v_add_f32 v25, v154, v25
  v_exp_f32 v25, v25
  v_mfma_f32_32x32x16_bf16 v[80:95], v[136:139], v[16:19], v[80:95]
  v_add_f32 v26, v154, v26
  v_exp_f32 v26, v26
  v_add_f32 v27, v154, v27
  v_exp_f32 v27, v27
  v_add_f32 v28, v154, v28
  v_exp_f32 v28, v28
  v_add_f32 v29, v154, v29
  v_exp_f32 v29, v29
  v_add_f32 v30, v154, v30
  v_exp_f32 v30, v30
  v_add_f32 v31, v154, v31
  v_exp_f32 v31, v31
  v_cvt_pk_bf16_f32 v20, v24, v25
  v_cvt_pk_bf16_f32 v21, v26, v27
  v_cvt_pk_bf16_f32 v22, v28, v29
  v_cvt_pk_bf16_f32 v23, v30, v31
  v_add_f32 v32, v155, v32
  v_exp_f32 v32, v32
  v_add_f32 v33, v155, v33
  v_exp_f32 v33, v33
  v_mfma_f32_32x32x16_bf16 v[80:95], v[140:143], v[20:23], v[80:95]
  v_add_f32 v34, v155, v34
  v_exp_f32 v34, v34
  v_add_f32 v35, v155, v35
  v_exp_f32 v35, v35
  v_add_f32 v36, v155, v36
  v_exp_f32 v36, v36
  v_add_f32 v37, v155, v37
  v_exp_f32 v37, v37
  s_waitcnt vmcnt(2)
  v_mfma_f32_32x32x16_bf16 v[16:31], v[132:135], v[112:115], 0
  v_add_f32 v38, v155, v38
  v_exp_f32 v38, v38
  v_add_f32 v39, v155, v39
  v_exp_f32 v39, v39
  v_cvt_pk_bf16_f32 v32, v32, v33
  v_cvt_pk_bf16_f32 v33, v34, v35
  v_cvt_pk_bf16_f32 v34, v36, v37
  v_cvt_pk_bf16_f32 v35, v38, v39
  v_add_f32 v40, v155, v40
  v_exp_f32 v40, v40
  v_add_f32 v41, v155, v41
  v_exp_f32 v41, v41
  v_mfma_f32_32x32x16_bf16 v[96:111], v[136:139], v[32:35], v[96:111]
  v_add_f32 v42, v155, v42
  v_exp_f32 v42, v42
  v_add_f32 v43, v155, v43
  v_exp_f32 v43, v43
  v_add_f32 v44, v155, v44
  v_exp_f32 v44, v44
  v_add_f32 v45, v155, v45
  v_exp_f32 v45, v45
  v_add_f32 v46, v155, v46
  v_exp_f32 v46, v46
  v_add_f32 v47, v155, v47
  v_exp_f32 v47, v47
  v_cvt_pk_bf16_f32 v36, v40, v41
  v_cvt_pk_bf16_f32 v37, v42, v43
  v_cvt_pk_bf16_f32 v38, v44, v45
  v_cvt_pk_bf16_f32 v39, v46, v47
  v_add_f32 v16, v152, v16
  v_exp_f32 v16, v16
  v_add_f32 v17, v152, v17
  v_exp_f32 v17, v17
  v_mfma_f32_32x32x16_bf16 v[96:111], v[140:143], v[36:39], v[96:111]
  v_add_f32 v18, v152, v18
  v_exp_f32 v18, v18
  v_add_f32 v19, v152, v19
  v_exp_f32 v19, v19
  v_add_f32 v20, v152, v20
  v_exp_f32 v20, v20
  v_add_f32 v21, v152, v21
  v_exp_f32 v21, v21
  v_mfma_f32_32x32x16_bf16 v[32:47], v[132:135], v[116:119], 0
  v_add_f32 v22, v152, v22
  v_exp_f32 v22, v22
  v_add_f32 v23, v152, v23
  v_exp_f32 v23, v23
  v_cvt_pk_bf16_f32 v16, v16, v17
  v_cvt_pk_bf16_f32 v17, v18, v19
  v_cvt_pk_bf16_f32 v18, v20, v21
  v_cvt_pk_bf16_f32 v19, v22, v23
  v_add_f32 v24, v152, v24
  v_exp_f32 v24, v24
  v_add_f32 v25, v152, v25
  v_exp_f32 v25, v25
  s_waitcnt vmcnt(0)
  v_mfma_f32_32x32x16_bf16 v[48:63], v[144:147], v[16:19], v[48:63]
  v_add_f32 v26, v152, v26
  v_exp_f32 v26, v26
  v_add_f32 v27, v152, v27
  v_exp_f32 v27, v27
  v_add_f32 v28, v152, v28
  v_exp_f32 v28, v28
  v_add_f32 v29, v152, v29
  v_exp_f32 v29, v29
  v_add_f32 v30, v152, v30
  v_exp_f32 v30, v30
  v_add_f32 v31, v152, v31
  v_exp_f32 v31, v31
  v_cvt_pk_bf16_f32 v20, v24, v25
  v_cvt_pk_bf16_f32 v21, v26, v27
  v_cvt_pk_bf16_f32 v22, v28, v29
  v_cvt_pk_bf16_f32 v23, v30, v31
  v_add_f32 v32, v153, v32
  v_exp_f32 v32, v32
  v_add_f32 v33, v153, v33
  v_exp_f32 v33, v33
  s_barrier
  v_mfma_f32_32x32x16_bf16 v[48:63], v[148:151], v[20:23], v[48:63]
  v_add_f32 v34, v153, v34
  v_exp_f32 v34, v34
  v_add_f32 v35, v153, v35
  v_exp_f32 v35, v35
  ds_read_b128 v[128:131], v12 offset:2048
  v_add_f32 v36, v153, v36
  v_exp_f32 v36, v36
  v_add_f32 v37, v153, v37
  v_exp_f32 v37, v37
  v_mfma_f32_32x32x16_bf16 v[16:31], v[132:135], v[120:123], 0
  v_add_f32 v38, v153, v38
  v_exp_f32 v38, v38
  v_add_f32 v39, v153, v39
  v_exp_f32 v39, v39
  v_cvt_pk_bf16_f32 v32, v32, v33
  v_cvt_pk_bf16_f32 v33, v34, v35
  v_cvt_pk_bf16_f32 v34, v36, v37
  v_cvt_pk_bf16_f32 v35, v38, v39
  v_add_f32 v40, v153, v40
  v_exp_f32 v40, v40
  v_add_f32 v41, v153, v41
  v_exp_f32 v41, v41
  v_mfma_f32_32x32x16_bf16 v[64:79], v[144:147], v[32:35], v[64:79]
  v_add_f32 v42, v153, v42
  v_exp_f32 v42, v42
  s_mov_b64 exec, s[20:21]
  ds_read_b128 v[136:139], v13 offset:2048
  ds_read_b128 v[140:143], v13 offset:2560
  s_mov_b64 exec, -1
  v_add_f32 v43, v153, v43
  v_exp_f32 v43, v43
  v_add_f32 v44, v153, v44
  v_exp_f32 v44, v44
  v_add_f32 v45, v153, v45
  v_exp_f32 v45, v45
  v_add_f32 v46, v153, v46
  v_exp_f32 v46, v46
  v_add_f32 v47, v153, v47
  v_exp_f32 v47, v47
  v_cvt_pk_bf16_f32 v36, v40, v41
  v_cvt_pk_bf16_f32 v37, v42, v43
  v_cvt_pk_bf16_f32 v38, v44, v45
  v_cvt_pk_bf16_f32 v39, v46, v47
  v_add_f32 v16, v154, v16
  v_exp_f32 v16, v16
  v_add_f32 v17, v154, v17
  v_exp_f32 v17, v17
  v_mfma_f32_32x32x16_bf16 v[64:79], v[148:151], v[36:39], v[64:79]
  v_add_f32 v18, v154, v18
  v_exp_f32 v18, v18
  v_add_f32 v19, v154, v19
  v_exp_f32 v19, v19
  v_add_f32 v20, v154, v20
  v_exp_f32 v20, v20
  v_add_f32 v21, v154, v21
  v_exp_f32 v21, v21
  v_mfma_f32_32x32x16_bf16 v[32:47], v[132:135], v[124:127], 0
  v_add_f32 v22, v154, v22
  v_exp_f32 v22, v22
  v_add_f32 v23, v154, v23
  v_exp_f32 v23, v23
  v_cvt_pk_bf16_f32 v16, v16, v17
  v_cvt_pk_bf16_f32 v17, v18, v19
  v_cvt_pk_bf16_f32 v18, v20, v21
  v_cvt_pk_bf16_f32 v19, v22, v23
  v_add_f32 v24, v154, v24
  v_exp_f32 v24, v24
  v_add_f32 v25, v154, v25
  v_exp_f32 v25, v25
  v_mfma_f32_32x32x16_bf16 v[80:95], v[144:147], v[16:19], v[80:95]
  v_add_f32 v26, v154, v26
  v_exp_f32 v26, v26
  v_add_f32 v27, v154, v27
  v_exp_f32 v27, v27
  v_add_f32 v28, v154, v28
  v_exp_f32 v28, v28
  v_add_f32 v29, v154, v29
  v_exp_f32 v29, v29
  v_add_f32 v30, v154, v30
  v_exp_f32 v30, v30
  v_add_f32 v31, v154, v31
  v_exp_f32 v31, v31
  v_cvt_pk_bf16_f32 v20, v24, v25
  v_cvt_pk_bf16_f32 v21, v26, v27
  v_cvt_pk_bf16_f32 v22, v28, v29
  v_cvt_pk_bf16_f32 v23, v30, v31
  v_add_f32 v32, v155, v32
  v_exp_f32 v32, v32
  v_add_f32 v33, v155, v33
  v_exp_f32 v33, v33
  v_mfma_f32_32x32x16_bf16 v[80:95], v[148:151], v[20:23], v[80:95]
  v_add_f32 v34, v155, v34
  v_exp_f32 v34, v34
  v_add_f32 v35, v155, v35
  v_exp_f32 v35, v35
  v_add_f32 v36, v155, v36
  v_exp_f32 v36, v36
  v_add_f32 v37, v155, v37
  v_exp_f32 v37, v37
  s_waitcnt lgkmcnt(2)
  v_mfma_f32_32x32x16_bf16 v[16:31], v[128:131], v[112:115], 0
  v_add_f32 v38, v155, v38
  v_exp_f32 v38, v38
  v_add_f32 v39, v155, v39
  v_exp_f32 v39, v39
  v_cvt_pk_bf16_f32 v32, v32, v33
  v_cvt_pk_bf16_f32 v33, v34, v35
  v_cvt_pk_bf16_f32 v34, v36, v37
  v_cvt_pk_bf16_f32 v35, v38, v39
  v_add_f32 v40, v155, v40
  v_exp_f32 v40, v40
  v_add_f32 v41, v155, v41
  v_exp_f32 v41, v41
  v_mfma_f32_32x32x16_bf16 v[96:111], v[144:147], v[32:35], v[96:111]
  v_add_f32 v42, v155, v42
  v_exp_f32 v42, v42
  v_add_f32 v43, v155, v43
  v_exp_f32 v43, v43
  v_add_f32 v44, v155, v44
  v_exp_f32 v44, v44
  v_add_f32 v45, v155, v45
  v_exp_f32 v45, v45
  v_add_f32 v46, v155, v46
  v_exp_f32 v46, v46
  v_add_f32 v47, v155, v47
  v_exp_f32 v47, v47
  v_cvt_pk_bf16_f32 v36, v40, v41
  v_cvt_pk_bf16_f32 v37, v42, v43
  v_cvt_pk_bf16_f32 v38, v44, v45
  v_cvt_pk_bf16_f32 v39, v46, v47
  v_add_u32 v12, 2048, v12
  v_add_u32 v13, 2048, v13
  s_mov_b32 s61, 0
concat_heads__ssm_conv_s4d__mha_block__prompt_kernel_loops:
  v_add_f32 v16, v152, v16
  v_exp_f32 v16, v16
  v_add_f32 v17, v152, v17
  v_exp_f32 v17, v17
  v_mfma_f32_32x32x16_bf16 v[96:111], v[148:151], v[36:39], v[96:111]
  v_add_f32 v18, v152, v18
  v_exp_f32 v18, v18
  v_add_f32 v19, v152, v19
  v_exp_f32 v19, v19
  v_add_f32 v20, v152, v20
  v_exp_f32 v20, v20
  v_add_f32 v21, v152, v21
  v_exp_f32 v21, v21
  v_mfma_f32_32x32x16_bf16 v[32:47], v[128:131], v[116:119], 0
  v_add_f32 v22, v152, v22
  v_exp_f32 v22, v22
  v_add_f32 v23, v152, v23
  v_exp_f32 v23, v23
  v_cvt_pk_bf16_f32 v16, v16, v17
  v_cvt_pk_bf16_f32 v17, v18, v19
  v_cvt_pk_bf16_f32 v18, v20, v21
  v_cvt_pk_bf16_f32 v19, v22, v23
  v_add_f32 v24, v152, v24
  v_exp_f32 v24, v24
  v_add_f32 v25, v152, v25
  v_exp_f32 v25, v25
  s_waitcnt lgkmcnt(0)
  v_mfma_f32_32x32x16_bf16 v[48:63], v[136:139], v[16:19], v[48:63]
  v_add_f32 v26, v152, v26
  v_exp_f32 v26, v26
  ds_read_b128 v[132:135], v12 offset:1024
  v_add_f32 v27, v152, v27
  v_exp_f32 v27, v27
  v_add_f32 v28, v152, v28
  v_exp_f32 v28, v28
  v_add_f32 v29, v152, v29
  v_exp_f32 v29, v29
  v_add_f32 v30, v152, v30
  v_exp_f32 v30, v30
  v_add_f32 v31, v152, v31
  v_exp_f32 v31, v31
  v_cvt_pk_bf16_f32 v20, v24, v25
  v_cvt_pk_bf16_f32 v21, v26, v27
  v_cvt_pk_bf16_f32 v22, v28, v29
  v_cvt_pk_bf16_f32 v23, v30, v31
  v_add_f32 v32, v153, v32
  v_exp_f32 v32, v32
  v_add_f32 v33, v153, v33
  v_exp_f32 v33, v33
  v_mfma_f32_32x32x16_bf16 v[48:63], v[140:143], v[20:23], v[48:63]
  v_add_f32 v34, v153, v34
  v_exp_f32 v34, v34
  v_add_f32 v35, v153, v35
  v_exp_f32 v35, v35
  v_add_f32 v36, v153, v36
  v_exp_f32 v36, v36
  v_add_f32 v37, v153, v37
  v_exp_f32 v37, v37
  v_mfma_f32_32x32x16_bf16 v[16:31], v[128:131], v[120:123], 0
  v_add_f32 v38, v153, v38
  v_exp_f32 v38, v38
  v_add_f32 v39, v153, v39
  v_exp_f32 v39, v39
  v_cvt_pk_bf16_f32 v32, v32, v33
  v_cvt_pk_bf16_f32 v33, v34, v35
  v_cvt_pk_bf16_f32 v34, v36, v37
  v_cvt_pk_bf16_f32 v35, v38, v39
  v_add_f32 v40, v153, v40
  v_exp_f32 v40, v40
  v_add_f32 v41, v153, v41
  v_exp_f32 v41, v41
  v_mfma_f32_32x32x16_bf16 v[64:79], v[136:139], v[32:35], v[64:79]
  v_add_f32 v42, v153, v42
  v_exp_f32 v42, v42
  s_mov_b64 exec, s[20:21]
  ds_read_b128 v[144:147], v13 offset:1024
  ds_read_b128 v[148:151], v13 offset:1536
  s_mov_b64 exec, -1
  v_add_f32 v43, v153, v43
  v_exp_f32 v43, v43
  v_add_f32 v44, v153, v44
  v_exp_f32 v44, v44
  v_add_f32 v45, v153, v45
  v_exp_f32 v45, v45
  v_add_f32 v46, v153, v46
  v_exp_f32 v46, v46
  v_add_f32 v47, v153, v47
  v_exp_f32 v47, v47
  v_cvt_pk_bf16_f32 v36, v40, v41
  v_cvt_pk_bf16_f32 v37, v42, v43
  v_cvt_pk_bf16_f32 v38, v44, v45
  v_cvt_pk_bf16_f32 v39, v46, v47
  v_add_f32 v16, v154, v16
  v_exp_f32 v16, v16
  v_add_f32 v17, v154, v17
  v_exp_f32 v17, v17
  v_mfma_f32_32x32x16_bf16 v[64:79], v[140:143], v[36:39], v[64:79]
  v_add_f32 v18, v154, v18
  v_exp_f32 v18, v18
  v_add_f32 v19, v154, v19
  v_exp_f32 v19, v19
  v_add_f32 v20, v154, v20
  v_exp_f32 v20, v20
  v_add_f32 v21, v154, v21
  v_exp_f32 v21, v21
  v_mfma_f32_32x32x16_bf16 v[32:47], v[128:131], v[124:127], 0
  v_add_f32 v22, v154, v22
  v_exp_f32 v22, v22
  v_add_f32 v23, v154, v23
  v_exp_f32 v23, v23
  v_cvt_pk_bf16_f32 v16, v16, v17
  v_cvt_pk_bf16_f32 v17, v18, v19
  v_cvt_pk_bf16_f32 v18, v20, v21
  v_cvt_pk_bf16_f32 v19, v22, v23
  v_add_f32 v24, v154, v24
  v_exp_f32 v24, v24
  v_add_f32 v25, v154, v25
  v_exp_f32 v25, v25
  v_mfma_f32_32x32x16_bf16 v[80:95], v[136:139], v[16:19], v[80:95]
  v_add_f32 v26, v154, v26
  v_exp_f32 v26, v26
  v_add_f32 v27, v154, v27
  v_exp_f32 v27, v27
  v_add_f32 v28, v154, v28
  v_exp_f32 v28, v28
  v_add_f32 v29, v154, v29
  v_exp_f32 v29, v29
  v_add_f32 v30, v154, v30
  v_exp_f32 v30, v30
  v_add_f32 v31, v154, v31
  v_exp_f32 v31, v31
  v_cvt_pk_bf16_f32 v20, v24, v25
  v_cvt_pk_bf16_f32 v21, v26, v27
  v_cvt_pk_bf16_f32 v22, v28, v29
  v_cvt_pk_bf16_f32 v23, v30, v31
  v_add_f32 v32, v155, v32
  v_exp_f32 v32, v32
  v_add_f32 v33, v155, v33
  v_exp_f32 v33, v33
  v_mfma_f32_32x32x16_bf16 v[80:95], v[140:143], v[20:23], v[80:95]
  v_add_f32 v34, v155, v34
  v_exp_f32 v34, v34
  v_add_f32 v35, v155, v35
  v_exp_f32 v35, v35
  v_add_f32 v36, v155, v36
  v_exp_f32 v36, v36
  v_add_f32 v37, v155, v37
  v_exp_f32 v37, v37
  s_waitcnt lgkmcnt(2)
  v_mfma_f32_32x32x16_bf16 v[16:31], v[132:135], v[112:115], 0
  v_add_f32 v38, v155, v38
  v_exp_f32 v38, v38
  v_add_f32 v39, v155, v39
  v_exp_f32 v39, v39
  v_cvt_pk_bf16_f32 v32, v32, v33
  v_cvt_pk_bf16_f32 v33, v34, v35
  v_cvt_pk_bf16_f32 v34, v36, v37
  v_cvt_pk_bf16_f32 v35, v38, v39
  v_add_f32 v40, v155, v40
  v_exp_f32 v40, v40
  v_add_f32 v41, v155, v41
  v_exp_f32 v41, v41
  v_mfma_f32_32x32x16_bf16 v[96:111], v[136:139], v[32:35], v[96:111]
  v_add_f32 v42, v155, v42
  v_exp_f32 v42, v42
  v_add_f32 v43, v155, v43
  v_exp_f32 v43, v43
  v_add_f32 v44, v155, v44
  v_exp_f32 v44, v44
  v_add_f32 v45, v155, v45
  v_exp_f32 v45, v45
  v_add_f32 v46, v155, v46
  v_exp_f32 v46, v46
  v_add_f32 v47, v155, v47
  v_exp_f32 v47, v47
  v_cvt_pk_bf16_f32 v36, v40, v41
  v_cvt_pk_bf16_f32 v37, v42, v43
  v_cvt_pk_bf16_f32 v38, v44, v45
  v_cvt_pk_bf16_f32 v39, v46, v47
  v_add_f32 v16, v152, v16
  v_exp_f32 v16, v16
  v_add_f32 v17, v152, v17
  v_exp_f32 v17, v17
  v_mfma_f32_32x32x16_bf16 v[96:111], v[140:143], v[36:39], v[96:111]
  v_add_f32 v18, v152, v18
  v_exp_f32 v18, v18
  v_add_f32 v19, v152, v19
  v_exp_f32 v19, v19
  v_add_f32 v20, v152, v20
  v_exp_f32 v20, v20
  v_add_f32 v21, v152, v21
  v_exp_f32 v21, v21
  v_mfma_f32_32x32x16_bf16 v[32:47], v[132:135], v[116:119], 0
  v_add_f32 v22, v152, v22
  v_exp_f32 v22, v22
  v_add_f32 v23, v152, v23
  v_exp_f32 v23, v23
  v_cvt_pk_bf16_f32 v16, v16, v17
  v_cvt_pk_bf16_f32 v17, v18, v19
  v_cvt_pk_bf16_f32 v18, v20, v21
  v_cvt_pk_bf16_f32 v19, v22, v23
  v_add_f32 v24, v152, v24
  v_exp_f32 v24, v24
  v_add_f32 v25, v152, v25
  v_exp_f32 v25, v25
  s_waitcnt lgkmcnt(0)
  v_mfma_f32_32x32x16_bf16 v[48:63], v[144:147], v[16:19], v[48:63]
  v_add_f32 v26, v152, v26
  v_exp_f32 v26, v26
  ds_read_b128 v[128:131], v12 offset:2048
  v_add_f32 v27, v152, v27
  v_exp_f32 v27, v27
  v_add_f32 v28, v152, v28
  v_exp_f32 v28, v28
  v_add_f32 v29, v152, v29
  v_exp_f32 v29, v29
  v_add_f32 v30, v152, v30
  v_exp_f32 v30, v30
  v_add_f32 v31, v152, v31
  v_exp_f32 v31, v31
  v_cvt_pk_bf16_f32 v20, v24, v25
  v_cvt_pk_bf16_f32 v21, v26, v27
  v_cvt_pk_bf16_f32 v22, v28, v29
  v_cvt_pk_bf16_f32 v23, v30, v31
  v_add_f32 v32, v153, v32
  v_exp_f32 v32, v32
  v_add_f32 v33, v153, v33
  v_exp_f32 v33, v33
  v_mfma_f32_32x32x16_bf16 v[48:63], v[148:151], v[20:23], v[48:63]
  v_add_f32 v34, v153, v34
  v_exp_f32 v34, v34
  v_add_f32 v35, v153, v35
  v_exp_f32 v35, v35
  v_add_f32 v36, v153, v36
  v_exp_f32 v36, v36
  v_add_f32 v37, v153, v37
  v_exp_f32 v37, v37
  v_mfma_f32_32x32x16_bf16 v[16:31], v[132:135], v[120:123], 0
  v_add_f32 v38, v153, v38
  v_exp_f32 v38, v38
  v_add_f32 v39, v153, v39
  v_exp_f32 v39, v39
  v_cvt_pk_bf16_f32 v32, v32, v33
  v_cvt_pk_bf16_f32 v33, v34, v35
  v_cvt_pk_bf16_f32 v34, v36, v37
  v_cvt_pk_bf16_f32 v35, v38, v39
  v_add_f32 v40, v153, v40
  v_exp_f32 v40, v40
  v_add_f32 v41, v153, v41
  v_exp_f32 v41, v41
  v_mfma_f32_32x32x16_bf16 v[64:79], v[144:147], v[32:35], v[64:79]
  v_add_f32 v42, v153, v42
  v_exp_f32 v42, v42
  s_mov_b64 exec, s[20:21]
  ds_read_b128 v[136:139], v13 offset:2048
  ds_read_b128 v[140:143], v13 offset:2560
  s_mov_b64 exec, -1
  v_add_f32 v43, v153, v43
  v_exp_f32 v43, v43
  v_add_f32 v44, v153, v44
  v_exp_f32 v44, v44
  v_add_f32 v45, v153, v45
  v_exp_f32 v45, v45
  v_add_f32 v46, v153, v46
  v_exp_f32 v46, v46
  v_add_f32 v47, v153, v47
  v_exp_f32 v47, v47
  v_cvt_pk_bf16_f32 v36, v40, v41
  v_cvt_pk_bf16_f32 v37, v42, v43
  v_cvt_pk_bf16_f32 v38, v44, v45
  v_cvt_pk_bf16_f32 v39, v46, v47
  v_add_f32 v16, v154, v16
  v_exp_f32 v16, v16
  v_add_f32 v17, v154, v17
  v_exp_f32 v17, v17
  v_mfma_f32_32x32x16_bf16 v[64:79], v[148:151], v[36:39], v[64:79]
  v_add_f32 v18, v154, v18
  v_exp_f32 v18, v18
  v_add_f32 v19, v154, v19
  v_exp_f32 v19, v19
  v_add_f32 v20, v154, v20
  v_exp_f32 v20, v20
  v_add_f32 v21, v154, v21
  v_exp_f32 v21, v21
  v_mfma_f32_32x32x16_bf16 v[32:47], v[132:135], v[124:127], 0
  v_add_f32 v22, v154, v22
  v_exp_f32 v22, v22
  v_add_f32 v23, v154, v23
  v_exp_f32 v23, v23
  v_cvt_pk_bf16_f32 v16, v16, v17
  v_cvt_pk_bf16_f32 v17, v18, v19
  v_cvt_pk_bf16_f32 v18, v20, v21
  v_cvt_pk_bf16_f32 v19, v22, v23
  v_add_f32 v24, v154, v24
  v_exp_f32 v24, v24
  v_add_f32 v25, v154, v25
  v_exp_f32 v25, v25
  v_mfma_f32_32x32x16_bf16 v[80:95], v[144:147], v[16:19], v[80:95]
  v_add_f32 v26, v154, v26
  v_exp_f32 v26, v26
  v_add_f32 v27, v154, v27
  v_exp_f32 v27, v27
  v_add_f32 v28, v154, v28
  v_exp_f32 v28, v28
  v_add_f32 v29, v154, v29
  v_exp_f32 v29, v29
  v_add_f32 v30, v154, v30
  v_exp_f32 v30, v30
  v_add_f32 v31, v154, v31
  v_exp_f32 v31, v31
  v_cvt_pk_bf16_f32 v20, v24, v25
  v_cvt_pk_bf16_f32 v21, v26, v27
  v_cvt_pk_bf16_f32 v22, v28, v29
  v_cvt_pk_bf16_f32 v23, v30, v31
  v_add_f32 v32, v155, v32
  v_exp_f32 v32, v32
  v_add_f32 v33, v155, v33
  v_exp_f32 v33, v33
  v_mfma_f32_32x32x16_bf16 v[80:95], v[148:151], v[20:23], v[80:95]
  v_add_f32 v34, v155, v34
  v_exp_f32 v34, v34
  v_add_f32 v35, v155, v35
  v_exp_f32 v35, v35
  v_add_f32 v36, v155, v36
  v_exp_f32 v36, v36
  v_add_f32 v37, v155, v37
  v_exp_f32 v37, v37
  s_waitcnt lgkmcnt(2)
  v_mfma_f32_32x32x16_bf16 v[16:31], v[128:131], v[112:115], 0
  v_add_f32 v38, v155, v38
  v_exp_f32 v38, v38
  v_add_f32 v39, v155, v39
  v_exp_f32 v39, v39
  v_cvt_pk_bf16_f32 v32, v32, v33
  v_cvt_pk_bf16_f32 v33, v34, v35
  v_cvt_pk_bf16_f32 v34, v36, v37
  v_cvt_pk_bf16_f32 v35, v38, v39
  v_add_f32 v40, v155, v40
  v_exp_f32 v40, v40
  v_add_f32 v41, v155, v41
  v_exp_f32 v41, v41
  v_mfma_f32_32x32x16_bf16 v[96:111], v[144:147], v[32:35], v[96:111]
  v_add_f32 v42, v155, v42
  v_exp_f32 v42, v42
  v_add_f32 v43, v155, v43
  v_exp_f32 v43, v43
  v_add_f32 v44, v155, v44
  v_exp_f32 v44, v44
  v_add_f32 v45, v155, v45
  v_exp_f32 v45, v45
  v_add_f32 v46, v155, v46
  v_exp_f32 v46, v46
  v_add_f32 v47, v155, v47
  v_exp_f32 v47, v47
  v_cvt_pk_bf16_f32 v36, v40, v41
  v_cvt_pk_bf16_f32 v37, v42, v43
  v_cvt_pk_bf16_f32 v38, v44, v45
  v_cvt_pk_bf16_f32 v39, v46, v47
  v_add_u32 v12, 2048, v12
  v_add_u32 v13, 2048, v13
  s_add_u32 s61, s61, 1
  s_cmp_lt_u32 s61, 6
  s_cbranch_scc1 concat_heads__ssm_conv_s4d__mha_block__prompt_kernel_loops
  v_add_f32 v16, v152, v16
  v_exp_f32 v16, v16
  v_add_f32 v17, v152, v17
  v_exp_f32 v17, v17
  v_mfma_f32_32x32x16_bf16 v[96:111], v[148:151], v[36:39], v[96:111]
  v_add_f32 v18, v152, v18
  v_exp_f32 v18, v18
  v_add_f32 v19, v152, v19
  v_exp_f32 v19, v19
  v_add_f32 v20, v152, v20
  v_exp_f32 v20, v20
  v_add_f32 v21, v152, v21
  v_exp_f32 v21, v21
  v_mfma_f32_32x32x16_bf16 v[32:47], v[128:131], v[116:119], 0
  v_add_f32 v22, v152, v22
  v_exp_f32 v22, v22
  v_add_f32 v23, v152, v23
  v_exp_f32 v23, v23
  v_cvt_pk_bf16_f32 v16, v16, v17
  v_cvt_pk_bf16_f32 v17, v18, v19
  v_cvt_pk_bf16_f32 v18, v20, v21
  v_cvt_pk_bf16_f32 v19, v22, v23
  v_add_f32 v24, v152, v24
  v_exp_f32 v24, v24
  v_add_f32 v25, v152, v25
  v_exp_f32 v25, v25
  s_waitcnt lgkmcnt(0)
  v_mfma_f32_32x32x16_bf16 v[48:63], v[136:139], v[16:19], v[48:63]
  v_add_f32 v26, v152, v26
  v_exp_f32 v26, v26
  ds_read_b128 v[132:135], v12 offset:1024
  v_add_f32 v27, v152, v27
  v_exp_f32 v27, v27
  v_add_f32 v28, v152, v28
  v_exp_f32 v28, v28
  v_add_f32 v29, v152, v29
  v_exp_f32 v29, v29
  v_add_f32 v30, v152, v30
  v_exp_f32 v30, v30
  v_add_f32 v31, v152, v31
  v_exp_f32 v31, v31
  v_cvt_pk_bf16_f32 v20, v24, v25
  v_cvt_pk_bf16_f32 v21, v26, v27
  v_cvt_pk_bf16_f32 v22, v28, v29
  v_cvt_pk_bf16_f32 v23, v30, v31
  v_add_f32 v32, v153, v32
  v_exp_f32 v32, v32
  v_add_f32 v33, v153, v33
  v_exp_f32 v33, v33
  v_mfma_f32_32x32x16_bf16 v[48:63], v[140:143], v[20:23], v[48:63]
  v_add_f32 v34, v153, v34
  v_exp_f32 v34, v34
  v_add_f32 v35, v153, v35
  v_exp_f32 v35, v35
  v_add_f32 v36, v153, v36
  v_exp_f32 v36, v36
  v_add_f32 v37, v153, v37
  v_exp_f32 v37, v37
  v_mfma_f32_32x32x16_bf16 v[16:31], v[128:131], v[120:123], 0
  v_add_f32 v38, v153, v38
  v_exp_f32 v38, v38
  v_add_f32 v39, v153, v39
  v_exp_f32 v39, v39
  v_cvt_pk_bf16_f32 v32, v32, v33
  v_cvt_pk_bf16_f32 v33, v34, v35
  v_cvt_pk_bf16_f32 v34, v36, v37
  v_cvt_pk_bf16_f32 v35, v38, v39
  v_add_f32 v40, v153, v40
  v_exp_f32 v40, v40
  v_add_f32 v41, v153, v41
  v_exp_f32 v41, v41
  v_mfma_f32_32x32x16_bf16 v[64:79], v[136:139], v[32:35], v[64:79]
  v_add_f32 v42, v153, v42
  v_exp_f32 v42, v42
  s_mov_b64 exec, s[20:21]
  ds_read_b128 v[144:147], v13 offset:1024
  ds_read_b128 v[148:151], v13 offset:1536
  s_mov_b64 exec, -1
  v_add_f32 v43, v153, v43
  v_exp_f32 v43, v43
  v_add_f32 v44, v153, v44
  v_exp_f32 v44, v44
  v_add_f32 v45, v153, v45
  v_exp_f32 v45, v45
  v_add_f32 v46, v153, v46
  v_exp_f32 v46, v46
  v_add_f32 v47, v153, v47
  v_exp_f32 v47, v47
  v_cvt_pk_bf16_f32 v36, v40, v41
  v_cvt_pk_bf16_f32 v37, v42, v43
  v_cvt_pk_bf16_f32 v38, v44, v45
  v_cvt_pk_bf16_f32 v39, v46, v47
  v_add_f32 v16, v154, v16
  v_exp_f32 v16, v16
  v_add_f32 v17, v154, v17
  v_exp_f32 v17, v17
  v_mfma_f32_32x32x16_bf16 v[64:79], v[140:143], v[36:39], v[64:79]
  v_add_f32 v18, v154, v18
  v_exp_f32 v18, v18
  v_add_f32 v19, v154, v19
  v_exp_f32 v19, v19
  v_add_f32 v20, v154, v20
  v_exp_f32 v20, v20
  v_add_f32 v21, v154, v21
  v_exp_f32 v21, v21
  v_mfma_f32_32x32x16_bf16 v[32:47], v[128:131], v[124:127], 0
  v_add_f32 v22, v154, v22
  v_exp_f32 v22, v22
  v_add_f32 v23, v154, v23
  v_exp_f32 v23, v23
  v_cvt_pk_bf16_f32 v16, v16, v17
  v_cvt_pk_bf16_f32 v17, v18, v19
  v_cvt_pk_bf16_f32 v18, v20, v21
  v_cvt_pk_bf16_f32 v19, v22, v23
  v_add_f32 v24, v154, v24
  v_exp_f32 v24, v24
  v_add_f32 v25, v154, v25
  v_exp_f32 v25, v25
  v_mfma_f32_32x32x16_bf16 v[80:95], v[136:139], v[16:19], v[80:95]
  v_add_f32 v26, v154, v26
  v_exp_f32 v26, v26
  v_add_f32 v27, v154, v27
  v_exp_f32 v27, v27
  v_add_f32 v28, v154, v28
  v_exp_f32 v28, v28
  v_add_f32 v29, v154, v29
  v_exp_f32 v29, v29
  v_add_f32 v30, v154, v30
  v_exp_f32 v30, v30
  v_add_f32 v31, v154, v31
  v_exp_f32 v31, v31
  v_cvt_pk_bf16_f32 v20, v24, v25
  v_cvt_pk_bf16_f32 v21, v26, v27
  v_cvt_pk_bf16_f32 v22, v28, v29
  v_cvt_pk_bf16_f32 v23, v30, v31
  v_add_f32 v32, v155, v32
  v_exp_f32 v32, v32
  v_add_f32 v33, v155, v33
  v_exp_f32 v33, v33
  v_mfma_f32_32x32x16_bf16 v[80:95], v[140:143], v[20:23], v[80:95]
  v_add_f32 v34, v155, v34
  v_exp_f32 v34, v34
  v_add_f32 v35, v155, v35
  v_exp_f32 v35, v35
  v_add_f32 v36, v155, v36
  v_exp_f32 v36, v36
  v_add_f32 v37, v155, v37
  v_exp_f32 v37, v37
  s_waitcnt lgkmcnt(2)
  v_mfma_f32_32x32x16_bf16 v[16:31], v[132:135], v[112:115], 0
  v_add_f32 v38, v155, v38
  v_exp_f32 v38, v38
  v_add_f32 v39, v155, v39
  v_exp_f32 v39, v39
  v_cvt_pk_bf16_f32 v32, v32, v33
  v_cvt_pk_bf16_f32 v33, v34, v35
  v_cvt_pk_bf16_f32 v34, v36, v37
  v_cvt_pk_bf16_f32 v35, v38, v39
  v_add_f32 v40, v155, v40
  v_exp_f32 v40, v40
  v_add_f32 v41, v155, v41
  v_exp_f32 v41, v41
  v_mfma_f32_32x32x16_bf16 v[96:111], v[136:139], v[32:35], v[96:111]
  v_add_f32 v42, v155, v42
  v_exp_f32 v42, v42
  v_add_f32 v43, v155, v43
  v_exp_f32 v43, v43
  v_add_f32 v44, v155, v44
  v_exp_f32 v44, v44
  v_add_f32 v45, v155, v45
  v_exp_f32 v45, v45
  v_add_f32 v46, v155, v46
  v_exp_f32 v46, v46
  v_add_f32 v47, v155, v47
  v_exp_f32 v47, v47
  v_cvt_pk_bf16_f32 v36, v40, v41
  v_cvt_pk_bf16_f32 v37, v42, v43
  v_cvt_pk_bf16_f32 v38, v44, v45
  v_cvt_pk_bf16_f32 v39, v46, v47
  v_add_f32 v16, v152, v16
  v_exp_f32 v16, v16
  v_add_f32 v17, v152, v17
  v_exp_f32 v17, v17
  v_mfma_f32_32x32x16_bf16 v[96:111], v[140:143], v[36:39], v[96:111]
  v_add_f32 v18, v152, v18
  v_exp_f32 v18, v18
  v_add_f32 v19, v152, v19
  v_exp_f32 v19, v19
  v_add_f32 v20, v152, v20
  v_exp_f32 v20, v20
  v_add_f32 v21, v152, v21
  v_exp_f32 v21, v21
  v_mfma_f32_32x32x16_bf16 v[32:47], v[132:135], v[116:119], 0
  v_add_f32 v22, v152, v22
  v_exp_f32 v22, v22
  v_add_f32 v23, v152, v23
  v_exp_f32 v23, v23
  v_cvt_pk_bf16_f32 v16, v16, v17
  v_cvt_pk_bf16_f32 v17, v18, v19
  v_cvt_pk_bf16_f32 v18, v20, v21
  v_cvt_pk_bf16_f32 v19, v22, v23
  v_add_f32 v24, v152, v24
  v_exp_f32 v24, v24
  v_add_f32 v25, v152, v25
  v_exp_f32 v25, v25
  s_waitcnt lgkmcnt(0)
  v_mfma_f32_32x32x16_bf16 v[48:63], v[144:147], v[16:19], v[48:63]
  v_add_f32 v26, v152, v26
  v_exp_f32 v26, v26
  v_add_f32 v27, v152, v27
  v_exp_f32 v27, v27
  v_add_f32 v28, v152, v28
  v_exp_f32 v28, v28
  v_add_f32 v29, v152, v29
  v_exp_f32 v29, v29
  v_add_f32 v30, v152, v30
  v_exp_f32 v30, v30
  v_add_f32 v31, v152, v31
  v_exp_f32 v31, v31
  v_cvt_pk_bf16_f32 v20, v24, v25
  v_cvt_pk_bf16_f32 v21, v26, v27
  v_cvt_pk_bf16_f32 v22, v28, v29
  v_cvt_pk_bf16_f32 v23, v30, v31
  v_add_f32 v32, v153, v32
  v_exp_f32 v32, v32
  v_add_f32 v33, v153, v33
  v_exp_f32 v33, v33
  v_mfma_f32_32x32x16_bf16 v[48:63], v[148:151], v[20:23], v[48:63]
  v_add_f32 v34, v153, v34
  v_exp_f32 v34, v34
  v_add_f32 v35, v153, v35
  v_exp_f32 v35, v35
  v_add_f32 v36, v153, v36
  v_exp_f32 v36, v36
  v_add_f32 v37, v153, v37
  v_exp_f32 v37, v37
  v_mfma_f32_32x32x16_bf16 v[16:31], v[132:135], v[120:123], 0
  v_add_f32 v38, v153, v38
  v_exp_f32 v38, v38
  v_add_f32 v39, v153, v39
  v_exp_f32 v39, v39
  v_cvt_pk_bf16_f32 v32, v32, v33
  v_cvt_pk_bf16_f32 v33, v34, v35
  v_cvt_pk_bf16_f32 v34, v36, v37
  v_cvt_pk_bf16_f32 v35, v38, v39
  v_add_f32 v40, v153, v40
  v_exp_f32 v40, v40
  v_add_f32 v41, v153, v41
  v_exp_f32 v41, v41
  v_mfma_f32_32x32x16_bf16 v[64:79], v[144:147], v[32:35], v[64:79]
  v_add_f32 v42, v153, v42
  v_exp_f32 v42, v42
  v_add_f32 v43, v153, v43
  v_exp_f32 v43, v43
  v_add_f32 v44, v153, v44
  v_exp_f32 v44, v44
  v_add_f32 v45, v153, v45
  v_exp_f32 v45, v45
  v_add_f32 v46, v153, v46
  v_exp_f32 v46, v46
  v_add_f32 v47, v153, v47
  v_exp_f32 v47, v47
  v_cvt_pk_bf16_f32 v36, v40, v41
  v_cvt_pk_bf16_f32 v37, v42, v43
  v_cvt_pk_bf16_f32 v38, v44, v45
  v_cvt_pk_bf16_f32 v39, v46, v47
  v_add_f32 v16, v154, v16
  v_exp_f32 v16, v16
  v_add_f32 v17, v154, v17
  v_exp_f32 v17, v17
  v_mfma_f32_32x32x16_bf16 v[64:79], v[148:151], v[36:39], v[64:79]
  v_add_f32 v18, v154, v18
  v_exp_f32 v18, v18
  v_add_f32 v19, v154, v19
  v_exp_f32 v19, v19
  v_add_f32 v20, v154, v20
  v_exp_f32 v20, v20
  v_add_f32 v21, v154, v21
  v_exp_f32 v21, v21
  v_mfma_f32_32x32x16_bf16 v[32:47], v[132:135], v[124:127], 0
  v_add_f32 v22, v154, v22
  v_exp_f32 v22, v22
  v_add_f32 v23, v154, v23
  v_exp_f32 v23, v23
  v_cvt_pk_bf16_f32 v16, v16, v17
  v_cvt_pk_bf16_f32 v17, v18, v19
  v_cvt_pk_bf16_f32 v18, v20, v21
  v_cvt_pk_bf16_f32 v19, v22, v23
  v_add_f32 v24, v154, v24
  v_exp_f32 v24, v24
  v_add_f32 v25, v154, v25
  v_exp_f32 v25, v25
  v_mfma_f32_32x32x16_bf16 v[80:95], v[144:147], v[16:19], v[80:95]
  v_add_f32 v26, v154, v26
  v_exp_f32 v26, v26
  v_add_f32 v27, v154, v27
  v_exp_f32 v27, v27
  v_add_f32 v28, v154, v28
  v_exp_f32 v28, v28
  v_add_f32 v29, v154, v29
  v_exp_f32 v29, v29
  v_add_f32 v30, v154, v30
  v_exp_f32 v30, v30
  v_add_f32 v31, v154, v31
  v_exp_f32 v31, v31
  v_cvt_pk_bf16_f32 v20, v24, v25
  v_cvt_pk_bf16_f32 v21, v26, v27
  v_cvt_pk_bf16_f32 v22, v28, v29
  v_cvt_pk_bf16_f32 v23, v30, v31
  v_add_f32 v32, v155, v32
  v_exp_f32 v32, v32
  v_add_f32 v33, v155, v33
  v_exp_f32 v33, v33
  v_mfma_f32_32x32x16_bf16 v[80:95], v[148:151], v[20:23], v[80:95]
  v_add_f32 v34, v155, v34
  v_exp_f32 v34, v34
  v_add_f32 v35, v155, v35
  v_exp_f32 v35, v35
  v_add_f32 v36, v155, v36
  v_exp_f32 v36, v36
  v_add_f32 v37, v155, v37
  v_exp_f32 v37, v37
  v_add_f32 v38, v155, v38
  v_exp_f32 v38, v38
  v_add_f32 v39, v155, v39
  v_exp_f32 v39, v39
  v_cvt_pk_bf16_f32 v32, v32, v33
  v_cvt_pk_bf16_f32 v33, v34, v35
  v_cvt_pk_bf16_f32 v34, v36, v37
  v_cvt_pk_bf16_f32 v35, v38, v39
  v_add_f32 v40, v155, v40
  v_exp_f32 v40, v40
  v_add_f32 v41, v155, v41
  v_exp_f32 v41, v41
  v_mfma_f32_32x32x16_bf16 v[96:111], v[144:147], v[32:35], v[96:111]
  v_add_f32 v42, v155, v42
  v_exp_f32 v42, v42
  v_add_f32 v43, v155, v43
  v_exp_f32 v43, v43
  v_add_f32 v44, v155, v44
  v_exp_f32 v44, v44
  v_add_f32 v45, v155, v45
  v_exp_f32 v45, v45
  v_add_f32 v46, v155, v46
  v_exp_f32 v46, v46
  v_add_f32 v47, v155, v47
  v_exp_f32 v47, v47
  v_cvt_pk_bf16_f32 v36, v40, v41
  v_cvt_pk_bf16_f32 v37, v42, v43
  v_cvt_pk_bf16_f32 v38, v44, v45
  v_cvt_pk_bf16_f32 v39, v46, v47
  s_nop 1
  v_mfma_f32_32x32x16_bf16 v[96:111], v[148:151], v[36:39], v[96:111]
  s_setprio 0
concat_heads__ssm_conv_s4d__mha_block__prompt_kernel_epi:
  v_mov_b32 v14, 0x5c800000
  v_mov_b32 v15, 0x21800000
  s_nop 7
  s_mov_b32 exec_hi, 0
  v_add_f32 v9, v56, v72
  v_add_f32 v10, v88, v104
  v_min3_f32 v12, v56, v72, v88
  v_add_f32 v9, v9, v10
  v_min_f32 v12, v12, v104
  v_cmp_nle_f32 s[44:45], v9, v14
  v_cmp_gt_f32 vcc, v15, v12
  s_mov_b64 exec, -1
  s_or_b64 s[44:45], s[44:45], vcc
  s_cmp_lg_u64 s[44:45], 0
  s_cselect_b32 s48, 1, 0
  v_cvt_pk_bf16_f32 v48, v48, v49
  v_cvt_pk_bf16_f32 v49, v50, v51
  v_cvt_pk_bf16_f32 v50, v52, v53
  v_cvt_pk_bf16_f32 v51, v54, v55
  v_cvt_pk_bf16_f32 v64, v64, v65
  v_cvt_pk_bf16_f32 v65, v66, v67
  v_cvt_pk_bf16_f32 v66, v68, v69
  v_cvt_pk_bf16_f32 v67, v70, v71
  v_cvt_pk_bf16_f32 v80, v80, v81
  v_cvt_pk_bf16_f32 v81, v82, v83
  v_cvt_pk_bf16_f32 v82, v84, v85
  v_cvt_pk_bf16_f32 v83, v86, v87
  v_cvt_pk_bf16_f32 v96, v96, v97
  v_cvt_pk_bf16_f32 v97, v98, v99
  v_cvt_pk_bf16_f32 v98, v100, v101
  v_cvt_pk_bf16_f32 v99, v102, v103
  s_mul_i32 s40, s29, 10240
  s_mul_i32 s41, s28, 5120
  s_add_u32 s40, s40, s41
  v_add_u32 v14, s40, v3
  v_lshlrev_b32 v15, 2, v2
  v_add_u32 v15, s40, v15
  s_lshl_b32 s49, s24, 2
  s_add_u32 s49, s49, 151872
  v_mov_b32 v10, s49
  v_mov_b32 v9, s48
  ds_write_b32 v10, v9
  s_barrier
  ds_write_b128 v14, v[48:51] offset:0
  ds_write_b32 v15, v56 offset:1024
  ds_write_b128 v14, v[64:67] offset:1280
  ds_write_b32 v15, v72 offset:2304
  ds_write_b128 v14, v[80:83] offset:2560
  ds_write_b32 v15, v88 offset:3584
  ds_write_b128 v14, v[96:99] offset:3840
  ds_write_b32 v15, v104 offset:4864
  s_waitcnt lgkmcnt(0)
  s_barrier
  s_mul_i32 s40, s24, 1280
  v_add_u32 v14, s40, v3
  v_and_b32 v15, 31, v2
  v_lshlrev_b32 v15, 2, v15
  v_add_u32 v15, s40, v15
  v_and_b32 v10, 7, v2
  v_lshlrev_b32 v10, 2, v10
  v_add_u32 v10, 151872, v10
  ds_read_b32 v9, v10
  ds_read_b128 v[16:19], v14 offset:0
  ds_read_b32 v48, v15 offset:1024
  ds_read_b128 v[20:23], v14 offset:10240
  ds_read_b32 v49, v15 offset:11264
  ds_read_b128 v[24:27], v14 offset:20480
  ds_read_b32 v50, v15 offset:21504
  ds_read_b128 v[28:31], v14 offset:30720
  ds_read_b32 v51, v15 offset:31744
  s_waitcnt lgkmcnt(0)
  v_cmp_ne_u32 vcc, 0, v9
  s_cmp_eq_u32 s60, 0
  s_cbranch_scc0 concat_heads__ssm_conv_s4d__mha_block__prompt_kernel_nofb
  s_cmp_lg_u64 vcc, 0
  s_cbranch_scc1 concat_heads__ssm_conv_s4d__mha_block__prompt_kernel_fallback
concat_heads__ssm_conv_s4d__mha_block__prompt_kernel_nofb:
  v_lshlrev_b32 v32, 16, v16
  v_and_b32 v33, 0xffff0000, v16
  v_lshlrev_b32 v40, 16, v20
  v_and_b32 v41, 0xffff0000, v20
  v_add_f32 v32, v32, v40
  v_add_f32 v33, v33, v41
  v_lshlrev_b32 v40, 16, v24
  v_and_b32 v41, 0xffff0000, v24
  v_add_f32 v32, v32, v40
  v_add_f32 v33, v33, v41
  v_lshlrev_b32 v40, 16, v28
  v_and_b32 v41, 0xffff0000, v28
  v_add_f32 v32, v32, v40
  v_add_f32 v33, v33, v41
  v_lshlrev_b32 v34, 16, v17
  v_and_b32 v35, 0xffff0000, v17
  v_lshlrev_b32 v40, 16, v21
  v_and_b32 v41, 0xffff0000, v21
  v_add_f32 v34, v34, v40
  v_add_f32 v35, v35, v41
  v_lshlrev_b32 v40, 16, v25
  v_and_b32 v41, 0xffff0000, v25
  v_add_f32 v34, v34, v40
  v_add_f32 v35, v35, v41
  v_lshlrev_b32 v40, 16, v29
  v_and_b32 v41, 0xffff0000, v29
  v_add_f32 v34, v34, v40
  v_add_f32 v35, v35, v41
  v_lshlrev_b32 v36, 16, v18
  v_and_b32 v37, 0xffff0000, v18
  v_lshlrev_b32 v40, 16, v22
  v_and_b32 v41, 0xffff0000, v22
  v_add_f32 v36, v36, v40
  v_add_f32 v37, v37, v41
  v_lshlrev_b32 v40, 16, v26
  v_and_b32 v41, 0xffff0000, v26
  v_add_f32 v36, v36, v40
  v_add_f32 v37, v37, v41
  v_lshlrev_b32 v40, 16, v30
  v_and_b32 v41, 0xffff0000, v30
  v_add_f32 v36, v36, v40
  v_add_f32 v37, v37, v41
  v_lshlrev_b32 v38, 16, v19
  v_and_b32 v39, 0xffff0000, v19
  v_lshlrev_b32 v40, 16, v23
  v_and_b32 v41, 0xffff0000, v23
  v_add_f32 v38, v38, v40
  v_add_f32 v39, v39, v41
  v_lshlrev_b32 v40, 16, v27
  v_and_b32 v41, 0xffff0000, v27
  v_add_f32 v38, v38, v40
  v_add_f32 v39, v39, v41
  v_lshlrev_b32 v40, 16, v31
  v_and_b32 v41, 0xffff0000, v31
  v_add_f32 v38, v38, v40
  v_add_f32 v39, v39, v41
  v_add_f32 v48, v48, v49
  v_add_f32 v50, v50, v51
  v_add_f32 v48, v48, v50
  v_rcp_f32 v49, v48
  v_and_b32 v14, 31, v2
  v_lshlrev_b32 v14, 4, v14
  v_mul_f32 v32, v32, v49
  v_mul_f32 v33, v33, v49
  v_mul_f32 v34, v34, v49
  v_mul_f32 v35, v35, v49
  v_mul_f32 v36, v36, v49
  v_mul_f32 v37, v37, v49
  v_mul_f32 v38, v38, v49
  v_mul_f32 v39, v39, v49
  v_cvt_pk_bf16_f32 v16, v32, v33
  v_cvt_pk_bf16_f32 v17, v34, v35
  v_cvt_pk_bf16_f32 v18, v36, v37
  v_cvt_pk_bf16_f32 v19, v38, v39
  s_lshl_b32 s46, s26, 13
  s_lshl_b32 s47, s24, 10
  s_add_u32 s46, s46, s47
  s_add_u32 s46, s46, s30
  s_add_u32 s46, s46, 6291456
  s_nop 0
  v_permlane32_swap_b32 v16, v18
  v_permlane32_swap_b32 v17, v19
  buffer_store_dwordx4 v[16:19], v3, s[12:15], s46 offen sc0 sc1
  s_branch concat_heads__ssm_conv_s4d__mha_block__prompt_kernel_e
concat_heads__ssm_conv_s4d__mha_block__prompt_kernel_fallback:
  s_mov_b32 s60, 1
  s_barrier
  s_branch concat_heads__ssm_conv_s4d__mha_block__prompt_kernel_restart
concat_heads__ssm_conv_s4d__mha_block__prompt_kernel_conv:
  s_setprio 3
  s_sub_u32 s25, s24, 8
  s_and_b32 s28, s25, 1
  s_lshr_b32 s25, s25, 1
  s_lshl_b32 s27, s2, 1
  s_add_u32 s27, s27, s25
  s_mul_i32 s29, s25, 10368
  s_add_u32 s29, s29, 131072
  s_lshl_b32 s51, s25, 15
  s_add_u32 s50, s30, s51
  s_cmp_eq_u32 s28, 0
  s_cbranch_scc0 concat_heads__ssm_conv_s4d__mha_block__prompt_kernel_ldk
  v_and_b32 v16, 31, v2
  v_mul_u32_u24 v16, 272, v16
  v_lshrrev_b32 v17, 5, v2
  v_lshl_add_u32 v16, v17, 4, v16
  s_mul_i32 s40, s25, 32768
  s_add_u32 s40, s40, 65536
  v_add_u32 v16, s40, v16
  ds_read_b128 v[32:35], v16 offset:0
  ds_read_b128 v[36:39], v16 offset:5712
  ds_read_b128 v[40:43], v16 offset:32
  ds_read_b128 v[44:47], v16 offset:5744
  ds_read_b128 v[48:51], v16 offset:64
  ds_read_b128 v[52:55], v16 offset:5776
  ds_read_b128 v[56:59], v16 offset:96
  ds_read_b128 v[60:63], v16 offset:5808
  s_waitcnt lgkmcnt(6)
  v_mfma_f32_32x32x16_bf16 v[96:111], v[32:35], v[36:39], 0
  s_waitcnt lgkmcnt(4)
  v_mfma_f32_32x32x16_bf16 v[96:111], v[40:43], v[44:47], v[96:111]
  s_waitcnt lgkmcnt(2)
  v_mfma_f32_32x32x16_bf16 v[96:111], v[48:51], v[52:55], v[96:111]
  s_waitcnt lgkmcnt(0)
  v_mfma_f32_32x32x16_bf16 v[96:111], v[56:59], v[60:63], v[96:111]
  ds_read_b128 v[32:35], v16 offset:128
  ds_read_b128 v[36:39], v16 offset:5840
  ds_read_b128 v[40:43], v16 offset:160
  ds_read_b128 v[44:47], v16 offset:5872
  ds_read_b128 v[48:51], v16 offset:192
  ds_read_b128 v[52:55], v16 offset:5904
  ds_read_b128 v[56:59], v16 offset:224
  ds_read_b128 v[60:63], v16 offset:5936
  s_waitcnt lgkmcnt(6)
  v_mfma_f32_32x32x16_bf16 v[96:111], v[32:35], v[36:39], v[96:111]
  s_waitcnt lgkmcnt(4)
  v_mfma_f32_32x32x16_bf16 v[96:111], v[40:43], v[44:47], v[96:111]
  s_waitcnt lgkmcnt(2)
  v_mfma_f32_32x32x16_bf16 v[96:111], v[48:51], v[52:55], v[96:111]
  s_waitcnt lgkmcnt(0)
  v_mfma_f32_32x32x16_bf16 v[96:111], v[56:59], v[60:63], v[96:111]
  ds_read_b128 v[32:35], v16 offset:14416
  ds_read_b128 v[36:39], v16 offset:20128
  ds_read_b128 v[40:43], v16 offset:14448
  ds_read_b128 v[44:47], v16 offset:20160
  ds_read_b128 v[48:51], v16 offset:14480
  ds_read_b128 v[52:55], v16 offset:20192
  ds_read_b128 v[56:59], v16 offset:14512
  ds_read_b128 v[60:63], v16 offset:20224
  s_waitcnt lgkmcnt(6)
  v_mfma_f32_32x32x16_bf16 v[96:111], v[32:35], v[36:39], v[96:111]
  s_waitcnt lgkmcnt(4)
  v_mfma_f32_32x32x16_bf16 v[96:111], v[40:43], v[44:47], v[96:111]
  s_waitcnt lgkmcnt(2)
  v_mfma_f32_32x32x16_bf16 v[96:111], v[48:51], v[52:55], v[96:111]
  s_waitcnt lgkmcnt(0)
  v_mfma_f32_32x32x16_bf16 v[96:111], v[56:59], v[60:63], v[96:111]
  ds_read_b128 v[32:35], v16 offset:14544
  ds_read_b128 v[36:39], v16 offset:20256
  ds_read_b128 v[40:43], v16 offset:14576
  ds_read_b128 v[44:47], v16 offset:20288
  ds_read_b128 v[48:51], v16 offset:14608
  ds_read_b128 v[52:55], v16 offset:20320
  ds_read_b128 v[56:59], v16 offset:14640
  ds_read_b128 v[60:63], v16 offset:20352
  s_waitcnt lgkmcnt(6)
  v_mfma_f32_32x32x16_bf16 v[96:111], v[32:35], v[36:39], v[96:111]
  s_waitcnt lgkmcnt(4)
  v_mfma_f32_32x32x16_bf16 v[96:111], v[40:43], v[44:47], v[96:111]
  s_waitcnt lgkmcnt(2)
  v_mfma_f32_32x32x16_bf16 v[96:111], v[48:51], v[52:55], v[96:111]
  s_waitcnt lgkmcnt(0)
  v_mfma_f32_32x32x16_bf16 v[96:111], v[56:59], v[60:63], v[96:111]
  v_and_b32 v12, 31, v2
  v_lshlrev_b32 v13, 4, v12
  v_lshl_add_u32 v13, v17, 3, v13
  v_add_u32 v13, s40, v13
  v_lshlrev_b32 v18, 2, v12
  v_add_u32 v18, s40, v18
  v_lshlrev_b32 v19, 1, v12
  v_add_u32 v19, s40, v19
  v_lshlrev_b32 v14, 3, v12
  v_add_u32 v14, s40, v14
  s_nop 3
  v_cvt_pk_bf16_f32 v40, v96, v97
  v_cvt_pk_bf16_f32 v41, v98, v99
  v_cvt_pk_bf16_f32 v42, v100, v101
  v_cvt_pk_bf16_f32 v43, v102, v103
  v_cvt_pk_bf16_f32 v44, v104, v105
  v_cvt_pk_bf16_f32 v45, v106, v107
  ds_write_b16 v13, v40 offset:0
  ds_write_b16_d16_hi v13, v40 offset:2
  ds_write_b16 v13, v41 offset:4
  ds_write_b16_d16_hi v13, v41 offset:6
  s_mov_b32 exec_hi, 0
  ds_write_b16 v14, v42 offset:512
  ds_write_b16_d16_hi v14, v42 offset:514
  ds_write_b16 v14, v43 offset:516
  ds_write_b16_d16_hi v14, v43 offset:518
  ds_write_b16 v19, v44 offset:1024
  ds_write_b16_d16_hi v19, v44 offset:1088
  ds_write_b16 v19, v45 offset:1152
  ds_write_b16_d16_hi v19, v45 offset:1216
  s_mov_b32 exec_lo, 0
  s_mov_b32 exec_hi, -1
  ds_write_b16 v18, v42 offset:768
  ds_write_b16_d16_hi v18, v42 offset:770
  ds_write_b16 v18, v43 offset:896
  ds_write_b16_d16_hi v18, v43 offset:898
  s_mov_b32 exec_hi, 1
  ds_write_b16 v19, v44 offset:1280
  s_mov_b64 exec, -1
  s_waitcnt lgkmcnt(0)
  v_add_u32 v13, s40, v3
  s_mov_b32 exec_hi, 0
  ds_read_b128 v[20:23], v13
  s_mov_b32 exec_lo, 0
  s_mov_b32 exec_hi, -1
  v_lshlrev_b32 v13, 3, v2
  v_add_u32 v13, s40, v13
  ds_read_b64 v[24:25], v13 offset:256
  ds_read_u16 v26, v13 offset:264
  s_mov_b64 exec, -1
  v_lshlrev_b32 v13, 2, v2
  v_add_u32 v13, s40, v13
  ds_read_b32 v27, v13 offset:768
  ds_read_u16 v28, v13 offset:772
  v_lshlrev_b32 v13, 1, v2
  v_add_u32 v13, s40, v13
  ds_read_u16 v29, v13 offset:1024
  ds_read_u16 v30, v13 offset:1026
  ds_read_u16 v31, v13 offset:1152
  ds_read_u16 v32, v13 offset:1154
  s_mov_b32 s41, 0x01000100
  s_mov_b32 s42, 0x03020302
  s_mov_b32 s43, 0x05040100
  s_mov_b32 s44, 0x05040302
  v_add_u32 v12, s29, v3
  v_and_b32 v33, 1, v2
  v_cmp_eq_u32 vcc, 0, v33
  s_waitcnt lgkmcnt(0)
  s_mov_b32 exec_lo, 0
  v_perm_b32 v20, v24, v24, s41
  v_perm_b32 v21, v25, v24, s44
  v_perm_b32 v22, v25, v25, s41
  v_perm_b32 v23, v26, v25, s44
  s_mov_b64 exec, -1
  ds_write_b128 v12, v[20:23] offset:64
  v_perm_b32 v36, v27, v27, s41
  v_mov_b32 v37, v27
  v_perm_b32 v38, v27, v27, s42
  v_perm_b32 v39, v28, v28, s41
  ds_write_b128 v12, v[36:39] offset:1088
  v_perm_b32 v48, v29, v29, s41
  v_mov_b32 v49, v48
  v_cndmask_b32 v50, v30, v29, vcc
  v_perm_b32 v50, v30, v50, s43
  v_perm_b32 v51, v30, v30, s41
  ds_write_b128 v12, v[48:51] offset:2112
  v_perm_b32 v52, v31, v31, s41
  v_mov_b32 v53, v52
  v_cndmask_b32 v54, v32, v31, vcc
  v_perm_b32 v54, v32, v54, s43
  v_perm_b32 v55, v32, v32, s41
  ds_write_b128 v12, v[52:55] offset:3136
  v_mov_b32 v4, 0
  v_mov_b32 v5, 0
  v_mov_b32 v6, 0
  v_mov_b32 v7, 0
  s_mov_b32 exec_hi, 0
  s_mov_b32 exec_lo, 0xf
  ds_write_b128 v12, v[4:7]
  s_mov_b32 exec_lo, 1
  s_lshl_b32 s41, s25, 4
  s_add_u32 s41, s41, 151808
  v_mov_b32 v9, s41
  ds_write_b128 v9, v[4:7]
  v_mov_b32 v9, 151840
  ds_write_b32 v9, v4
  s_mov_b64 exec, -1
  s_waitcnt lgkmcnt(0)
  v_mov_b32 v9, 151856
  s_mov_b32 s62, 0
concat_heads__ssm_conv_s4d__mha_block__prompt_kernel_wr1:
  ds_read_b32 v8, v9
  s_waitcnt lgkmcnt(0)
  v_readfirstlane_b32 s63, v8
  s_add_u32 s62, s62, 1
  s_cmp_eq_u32 s63, 1
  s_cbranch_scc1 concat_heads__ssm_conv_s4d__mha_block__prompt_kernel_wr1_x
  s_sleep 1
  s_cmp_lt_u32 s62, 0x400000
  s_cbranch_scc1 concat_heads__ssm_conv_s4d__mha_block__prompt_kernel_wr1
concat_heads__ssm_conv_s4d__mha_block__prompt_kernel_wr1_x:
  s_barrier
  s_add_u32 m0, s51, 67584
  s_add_u32 s52, s50, 4196352
  buffer_load_dwordx4 v3, s[12:15], s52 offen sc1 lds
  s_add_u32 m0, s51, 68608
  s_add_u32 s52, s50, 4197376
  buffer_load_dwordx4 v3, s[12:15], s52 offen sc1 lds
  s_add_u32 m0, s51, 69632
  s_add_u32 s52, s50, 4198400
  buffer_load_dwordx4 v3, s[12:15], s52 offen sc1 lds
  s_add_u32 m0, s51, 70656
  s_add_u32 s52, s50, 4199424
  buffer_load_dwordx4 v3, s[12:15], s52 offen sc1 lds
  s_add_u32 m0, s51, 71680
  s_add_u32 s52, s50, 4200448
  buffer_load_dwordx4 v3, s[12:15], s52 offen sc1 lds
  s_add_u32 m0, s51, 72704
  s_add_u32 s52, s50, 4201472
  buffer_load_dwordx4 v3, s[12:15], s52 offen sc1 lds
  s_add_u32 m0, s51, 73728
  s_add_u32 s52, s50, 4202496
  buffer_load_dwordx4 v3, s[12:15], s52 offen sc1 lds
  s_add_u32 m0, s51, 74752
  s_add_u32 s52, s50, 4203520
  buffer_load_dwordx4 v3, s[12:15], s52 offen sc1 lds
  s_add_u32 m0, s51, 75776
  s_add_u32 s52, s50, 4204544
  buffer_load_dwordx4 v3, s[12:15], s52 offen sc1 lds
  s_add_u32 m0, s51, 76800
  s_add_u32 s52, s50, 4205568
  buffer_load_dwordx4 v3, s[12:15], s52 offen sc1 lds
  s_add_u32 m0, s51, 77824
  s_add_u32 s52, s50, 4206592
  buffer_load_dwordx4 v3, s[12:15], s52 offen sc1 lds
  s_add_u32 m0, s51, 78848
  s_add_u32 s52, s50, 4207616
  buffer_load_dwordx4 v3, s[12:15], s52 offen sc1 lds
  s_add_u32 m0, s51, 79872
  s_add_u32 s52, s50, 4208640
  buffer_load_dwordx4 v3, s[12:15], s52 offen sc1 lds
  s_add_u32 m0, s51, 80896
  s_add_u32 s52, s50, 4209664
  buffer_load_dwordx4 v3, s[12:15], s52 offen sc1 lds
  s_add_u32 m0, s51, 83968
  s_add_u32 s52, s50, 4212736
  buffer_load_dwordx4 v3, s[12:15], s52 offen sc1 lds
  s_add_u32 m0, s51, 84992
  s_add_u32 s52, s50, 4213760
  buffer_load_dwordx4 v3, s[12:15], s52 offen sc1 lds
  s_add_u32 m0, s51, 86016
  s_add_u32 s52, s50, 4214784
  buffer_load_dwordx4 v3, s[12:15], s52 offen sc1 lds
  s_add_u32 m0, s51, 87040
  s_add_u32 s52, s50, 4215808
  buffer_load_dwordx4 v3, s[12:15], s52 offen sc1 lds
  s_add_u32 m0, s51, 88064
  s_add_u32 s52, s50, 4216832
  buffer_load_dwordx4 v3, s[12:15], s52 offen sc1 lds
  s_add_u32 m0, s51, 89088
  s_add_u32 s52, s50, 4217856
  buffer_load_dwordx4 v3, s[12:15], s52 offen sc1 lds
  s_add_u32 m0, s51, 90112
  s_add_u32 s52, s50, 4218880
  buffer_load_dwordx4 v3, s[12:15], s52 offen sc1 lds
  s_add_u32 m0, s51, 91136
  s_add_u32 s52, s50, 4219904
  buffer_load_dwordx4 v3, s[12:15], s52 offen sc1 lds
  s_add_u32 m0, s51, 92160
  s_add_u32 s52, s50, 4220928
  buffer_load_dwordx4 v3, s[12:15], s52 offen sc1 lds
  s_add_u32 m0, s51, 93184
  s_add_u32 s52, s50, 4221952
  buffer_load_dwordx4 v3, s[12:15], s52 offen sc1 lds
  s_add_u32 m0, s51, 94208
  s_add_u32 s52, s50, 4222976
  buffer_load_dwordx4 v3, s[12:15], s52 offen sc1 lds
  s_add_u32 m0, s51, 95232
  s_add_u32 s52, s50, 4224000
  buffer_load_dwordx4 v3, s[12:15], s52 offen sc1 lds
  s_add_u32 m0, s51, 96256
  s_add_u32 s52, s50, 4225024
  buffer_load_dwordx4 v3, s[12:15], s52 offen sc1 lds
  s_add_u32 m0, s51, 97280
  s_add_u32 s52, s50, 4226048
  buffer_load_dwordx4 v3, s[12:15], s52 offen sc1 lds
  s_branch concat_heads__ssm_conv_s4d__mha_block__prompt_kernel_ldd
concat_heads__ssm_conv_s4d__mha_block__prompt_kernel_ldk:
  v_mov_b32 v9, 151856
  s_mov_b32 s62, 0
concat_heads__ssm_conv_s4d__mha_block__prompt_kernel_wr2:
  ds_read_b32 v8, v9
  s_waitcnt lgkmcnt(0)
  v_readfirstlane_b32 s63, v8
  s_add_u32 s62, s62, 1
  s_cmp_eq_u32 s63, 1
  s_cbranch_scc1 concat_heads__ssm_conv_s4d__mha_block__prompt_kernel_wr2_x
  s_sleep 1
  s_cmp_lt_u32 s62, 0x400000
  s_cbranch_scc1 concat_heads__ssm_conv_s4d__mha_block__prompt_kernel_wr2
concat_heads__ssm_conv_s4d__mha_block__prompt_kernel_wr2_x:
  s_barrier
  s_add_u32 m0, s51, 2048
  s_add_u32 s52, s50, 2099200
  buffer_load_dwordx4 v3, s[12:15], s52 offen sc1 lds
  s_add_u32 m0, s51, 3072
  s_add_u32 s52, s50, 2100224
  buffer_load_dwordx4 v3, s[12:15], s52 offen sc1 lds
  s_add_u32 m0, s51, 4096
  s_add_u32 s52, s50, 2101248
  buffer_load_dwordx4 v3, s[12:15], s52 offen sc1 lds
  s_add_u32 m0, s51, 5120
  s_add_u32 s52, s50, 2102272
  buffer_load_dwordx4 v3, s[12:15], s52 offen sc1 lds
  s_add_u32 m0, s51, 6144
  s_add_u32 s52, s50, 2103296
  buffer_load_dwordx4 v3, s[12:15], s52 offen sc1 lds
  s_add_u32 m0, s51, 7168
  s_add_u32 s52, s50, 2104320
  buffer_load_dwordx4 v3, s[12:15], s52 offen sc1 lds
  s_add_u32 m0, s51, 8192
  s_add_u32 s52, s50, 2105344
  buffer_load_dwordx4 v3, s[12:15], s52 offen sc1 lds
  s_add_u32 m0, s51, 9216
  s_add_u32 s52, s50, 2106368
  buffer_load_dwordx4 v3, s[12:15], s52 offen sc1 lds
  s_add_u32 m0, s51, 10240
  s_add_u32 s52, s50, 2107392
  buffer_load_dwordx4 v3, s[12:15], s52 offen sc1 lds
  s_add_u32 m0, s51, 11264
  s_add_u32 s52, s50, 2108416
  buffer_load_dwordx4 v3, s[12:15], s52 offen sc1 lds
  s_add_u32 m0, s51, 12288
  s_add_u32 s52, s50, 2109440
  buffer_load_dwordx4 v3, s[12:15], s52 offen sc1 lds
  s_add_u32 m0, s51, 13312
  s_add_u32 s52, s50, 2110464
  buffer_load_dwordx4 v3, s[12:15], s52 offen sc1 lds
  s_add_u32 m0, s51, 14336
  s_add_u32 s52, s50, 2111488
  buffer_load_dwordx4 v3, s[12:15], s52 offen sc1 lds
  s_add_u32 m0, s51, 15360
  s_add_u32 s52, s50, 2112512
  buffer_load_dwordx4 v3, s[12:15], s52 offen sc1 lds
  s_add_u32 m0, s51, 18432
  s_add_u32 s52, s50, 2115584
  buffer_load_dwordx4 v3, s[12:15], s52 offen sc1 lds
  s_add_u32 m0, s51, 19456
  s_add_u32 s52, s50, 2116608
  buffer_load_dwordx4 v3, s[12:15], s52 offen sc1 lds
  s_add_u32 m0, s51, 20480
  s_add_u32 s52, s50, 2117632
  buffer_load_dwordx4 v3, s[12:15], s52 offen sc1 lds
  s_add_u32 m0, s51, 21504
  s_add_u32 s52, s50, 2118656
  buffer_load_dwordx4 v3, s[12:15], s52 offen sc1 lds
  s_add_u32 m0, s51, 22528
  s_add_u32 s52, s50, 2119680
  buffer_load_dwordx4 v3, s[12:15], s52 offen sc1 lds
  s_add_u32 m0, s51, 23552
  s_add_u32 s52, s50, 2120704
  buffer_load_dwordx4 v3, s[12:15], s52 offen sc1 lds
  s_add_u32 m0, s51, 24576
  s_add_u32 s52, s50, 2121728
  buffer_load_dwordx4 v3, s[12:15], s52 offen sc1 lds
  s_add_u32 m0, s51, 25600
  s_add_u32 s52, s50, 2122752
  buffer_load_dwordx4 v3, s[12:15], s52 offen sc1 lds
  s_add_u32 m0, s51, 26624
  s_add_u32 s52, s50, 2123776
  buffer_load_dwordx4 v3, s[12:15], s52 offen sc1 lds
  s_add_u32 m0, s51, 27648
  s_add_u32 s52, s50, 2124800
  buffer_load_dwordx4 v3, s[12:15], s52 offen sc1 lds
  s_add_u32 m0, s51, 28672
  s_add_u32 s52, s50, 2125824
  buffer_load_dwordx4 v3, s[12:15], s52 offen sc1 lds
  s_add_u32 m0, s51, 29696
  s_add_u32 s52, s50, 2126848
  buffer_load_dwordx4 v3, s[12:15], s52 offen sc1 lds
  s_add_u32 m0, s51, 30720
  s_add_u32 s52, s50, 2127872
  buffer_load_dwordx4 v3, s[12:15], s52 offen sc1 lds
  s_add_u32 m0, s51, 31744
  s_add_u32 s52, s50, 2128896
  buffer_load_dwordx4 v3, s[12:15], s52 offen sc1 lds
  s_lshl_b32 s40, s27, 12
  s_add_u32 s40, s40, 8388608
  s_add_u32 m0, s29, 4736
  s_add_u32 s41, s40, 0
  buffer_load_dwordx4 v3, s[12:15], s41 offen sc1 lds
  s_add_u32 m0, s29, 6272
  s_add_u32 s41, s40, 1024
  buffer_load_dwordx4 v3, s[12:15], s41 offen sc1 lds
  s_add_u32 m0, s29, 7808
  s_add_u32 s41, s40, 2048
  buffer_load_dwordx4 v3, s[12:15], s41 offen sc1 lds
  s_add_u32 m0, s29, 9344
  s_add_u32 s41, s40, 3072
  buffer_load_dwordx4 v3, s[12:15], s41 offen sc1 lds
  v_mov_b32 v4, 0
  v_mov_b32 v5, 0
  v_mov_b32 v6, 0
  v_mov_b32 v7, 0
  v_add_u32 v8, s29, v3
  s_mov_b32 exec_hi, 0
  ds_write_b128 v8, v[4:7] offset:4224
  ds_write_b128 v8, v[4:7] offset:5760
  ds_write_b128 v8, v[4:7] offset:7296
  ds_write_b128 v8, v[4:7] offset:8832
  s_mov_b64 exec, -1
concat_heads__ssm_conv_s4d__mha_block__prompt_kernel_ldd:
  v_bfe_u32 v4, v2, 4, 1
  v_lshlrev_b32 v4, 5, v4
  v_and_b32 v5, 3, v2
  v_lshl_add_u32 v4, v5, 3, v4
  v_lshrrev_b32 v5, 5, v2
  v_lshlrev_b32 v6, 6, v5
  v_sub_u32 v4, v4, v6
  v_bfe_u32 v6, v2, 2, 2
  v_lshlrev_b32 v6, 3, v6
  v_sub_u32 v4, v4, v6
  s_cmp_eq_u32 s28, 0
  s_mov_b32 s35, 3968
  s_cselect_b32 s35, 1920, s35
  s_add_u32 s35, s35, s29
  s_add_u32 s35, s35, 96
  v_add_u32 v10, s35, v4
  v_and_b32 v4, 31, v2
  v_add_u32 v4, v4, v5
  v_lshlrev_b32 v4, 4, v4
  s_add_u32 s35, s29, 4240
  v_add_u32 v11, s35, v4
  s_cmp_eq_u32 s28, 0
  s_cselect_b32 s36, 16, 32
  s_waitcnt vmcnt(0) lgkmcnt(0)
  s_barrier
  v_subrev_u32 v10, 384, v10
  ds_read_b64_tr_b16 v[80:81], v10 offset:416
  ds_read_b64_tr_b16 v[82:83], v10 offset:384
  ds_read_b128 v[88:91], v11 offset:0
  s_waitcnt lgkmcnt(0)
  v_mfma_f32_32x32x16_bf16 v[16:31], v[80:83], v[88:91], 0
  ds_read_b128 v[92:95], v11 offset:1536
  s_waitcnt lgkmcnt(0)
  v_mfma_f32_32x32x16_bf16 v[32:47], v[80:83], v[92:95], 0
  ds_read_b128 v[96:99], v11 offset:3072
  s_waitcnt lgkmcnt(0)
  v_mfma_f32_32x32x16_bf16 v[48:63], v[80:83], v[96:99], 0
  ds_read_b128 v[100:103], v11 offset:4608
  s_waitcnt lgkmcnt(0)
  v_mfma_f32_32x32x16_bf16 v[64:79], v[80:83], v[100:103], 0
  ds_read_b64_tr_b16 v[80:81], v10 offset:288
  ds_read_b64_tr_b16 v[82:83], v10 offset:256
  ds_read_b128 v[88:91], v11 offset:32
  s_waitcnt lgkmcnt(0)
  v_mfma_f32_32x32x16_bf16 v[16:31], v[80:83], v[88:91], v[16:31]
  ds_read_b128 v[92:95], v11 offset:1568
  s_waitcnt lgkmcnt(0)
  v_mfma_f32_32x32x16_bf16 v[32:47], v[80:83], v[92:95], v[32:47]
  ds_read_b128 v[96:99], v11 offset:3104
  s_waitcnt lgkmcnt(0)
  v_mfma_f32_32x32x16_bf16 v[48:63], v[80:83], v[96:99], v[48:63]
  ds_read_b128 v[100:103], v11 offset:4640
  s_waitcnt lgkmcnt(0)
  v_mfma_f32_32x32x16_bf16 v[64:79], v[80:83], v[100:103], v[64:79]
  ds_read_b64_tr_b16 v[80:81], v10 offset:160
  ds_read_b64_tr_b16 v[82:83], v10 offset:128
  ds_read_b128 v[88:91], v11 offset:64
  s_waitcnt lgkmcnt(0)
  v_mfma_f32_32x32x16_bf16 v[16:31], v[80:83], v[88:91], v[16:31]
  ds_read_b128 v[92:95], v11 offset:1600
  s_waitcnt lgkmcnt(0)
  v_mfma_f32_32x32x16_bf16 v[32:47], v[80:83], v[92:95], v[32:47]
  ds_read_b128 v[96:99], v11 offset:3136
  s_waitcnt lgkmcnt(0)
  v_mfma_f32_32x32x16_bf16 v[48:63], v[80:83], v[96:99], v[48:63]
  ds_read_b128 v[100:103], v11 offset:4672
  s_waitcnt lgkmcnt(0)
  v_mfma_f32_32x32x16_bf16 v[64:79], v[80:83], v[100:103], v[64:79]
  ds_read_b64_tr_b16 v[80:81], v10 offset:32
  ds_read_b64_tr_b16 v[82:83], v10 offset:0
  ds_read_b128 v[88:91], v11 offset:96
  s_waitcnt lgkmcnt(0)
  v_mfma_f32_32x32x16_bf16 v[16:31], v[80:83], v[88:91], v[16:31]
  ds_read_b128 v[92:95], v11 offset:1632
  s_waitcnt lgkmcnt(0)
  v_mfma_f32_32x32x16_bf16 v[32:47], v[80:83], v[92:95], v[32:47]
  ds_read_b128 v[96:99], v11 offset:3168
  s_waitcnt lgkmcnt(0)
  v_mfma_f32_32x32x16_bf16 v[48:63], v[80:83], v[96:99], v[48:63]
  ds_read_b128 v[100:103], v11 offset:4704
  s_waitcnt lgkmcnt(0)
  v_mfma_f32_32x32x16_bf16 v[64:79], v[80:83], v[100:103], v[64:79]
  v_subrev_u32 v10, 512, v10
  v_add_u32 v11, 128, v11
  s_mov_b32 s37, 4
concat_heads__ssm_conv_s4d__mha_block__prompt_kernel_cloop:
  ds_read_b64_tr_b16 v[80:81], v10 offset:416
  ds_read_b64_tr_b16 v[82:83], v10 offset:384
  ds_read_b128 v[88:91], v11 offset:0
  s_waitcnt lgkmcnt(0)
  v_mfma_f32_32x32x16_bf16 v[16:31], v[80:83], v[88:91], v[16:31]
  ds_read_b128 v[92:95], v11 offset:1536
  s_waitcnt lgkmcnt(0)
  v_mfma_f32_32x32x16_bf16 v[32:47], v[80:83], v[92:95], v[32:47]
  ds_read_b128 v[96:99], v11 offset:3072
  s_waitcnt lgkmcnt(0)
  v_mfma_f32_32x32x16_bf16 v[48:63], v[80:83], v[96:99], v[48:63]
  ds_read_b128 v[100:103], v11 offset:4608
  s_waitcnt lgkmcnt(0)
  v_mfma_f32_32x32x16_bf16 v[64:79], v[80:83], v[100:103], v[64:79]
  ds_read_b64_tr_b16 v[80:81], v10 offset:288
  ds_read_b64_tr_b16 v[82:83], v10 offset:256
  ds_read_b128 v[88:91], v11 offset:32
  s_waitcnt lgkmcnt(0)
  v_mfma_f32_32x32x16_bf16 v[16:31], v[80:83], v[88:91], v[16:31]
  ds_read_b128 v[92:95], v11 offset:1568
  s_waitcnt lgkmcnt(0)
  v_mfma_f32_32x32x16_bf16 v[32:47], v[80:83], v[92:95], v[32:47]
  ds_read_b128 v[96:99], v11 offset:3104
  s_waitcnt lgkmcnt(0)
  v_mfma_f32_32x32x16_bf16 v[48:63], v[80:83], v[96:99], v[48:63]
  ds_read_b128 v[100:103], v11 offset:4640
  s_waitcnt lgkmcnt(0)
  v_mfma_f32_32x32x16_bf16 v[64:79], v[80:83], v[100:103], v[64:79]
  ds_read_b64_tr_b16 v[80:81], v10 offset:160
  ds_read_b64_tr_b16 v[82:83], v10 offset:128
  ds_read_b128 v[88:91], v11 offset:64
  s_waitcnt lgkmcnt(0)
  v_mfma_f32_32x32x16_bf16 v[16:31], v[80:83], v[88:91], v[16:31]
  ds_read_b128 v[92:95], v11 offset:1600
  s_waitcnt lgkmcnt(0)
  v_mfma_f32_32x32x16_bf16 v[32:47], v[80:83], v[92:95], v[32:47]
  ds_read_b128 v[96:99], v11 offset:3136
  s_waitcnt lgkmcnt(0)
  v_mfma_f32_32x32x16_bf16 v[48:63], v[80:83], v[96:99], v[48:63]
  ds_read_b128 v[100:103], v11 offset:4672
  s_waitcnt lgkmcnt(0)
  v_mfma_f32_32x32x16_bf16 v[64:79], v[80:83], v[100:103], v[64:79]
  ds_read_b64_tr_b16 v[80:81], v10 offset:32
  ds_read_b64_tr_b16 v[82:83], v10 offset:0
  ds_read_b128 v[88:91], v11 offset:96
  s_waitcnt lgkmcnt(0)
  v_mfma_f32_32x32x16_bf16 v[16:31], v[80:83], v[88:91], v[16:31]
  ds_read_b128 v[92:95], v11 offset:1632
  s_waitcnt lgkmcnt(0)
  v_mfma_f32_32x32x16_bf16 v[32:47], v[80:83], v[92:95], v[32:47]
  ds_read_b128 v[96:99], v11 offset:3168
  s_waitcnt lgkmcnt(0)
  v_mfma_f32_32x32x16_bf16 v[48:63], v[80:83], v[96:99], v[48:63]
  ds_read_b128 v[100:103], v11 offset:4704
  s_waitcnt lgkmcnt(0)
  v_mfma_f32_32x32x16_bf16 v[64:79], v[80:83], v[100:103], v[64:79]
  v_subrev_u32 v10, 512, v10
  v_add_u32 v11, 128, v11
  s_add_u32 s37, s37, 4
  s_cmp_lt_u32 s37, s36
  s_cbranch_scc1 concat_heads__ssm_conv_s4d__mha_block__prompt_kernel_cloop
  v_xor_b32 v6, 32, v2
  v_lshlrev_b32 v6, 2, v6
  v_add_u32 v7, 31, v2
  v_and_b32 v7, 63, v7
  v_lshlrev_b32 v7, 2, v7
  s_lshl_b32 s35, s25, 4
  s_add_u32 s35, s35, 151808
  s_nop 7
  s_nop 1
  v_add_f32 v65, v65, v50
  v_add_f32 v66, v66, v51
  v_add_f32 v65, v65, v35
  v_add_f32 v69, v69, v54
  v_add_f32 v70, v70, v55
  v_add_f32 v69, v69, v39
  v_add_f32 v73, v73, v58
  v_add_f32 v74, v74, v59
  v_add_f32 v73, v73, v43
  v_add_f32 v77, v77, v62
  v_add_f32 v78, v78, v63
  v_add_f32 v77, v77, v47
  s_cmp_eq_u32 s28, 0
  s_cbranch_scc0 concat_heads__ssm_conv_s4d__mha_block__prompt_kernel_nopub
  s_mov_b32 exec_lo, 0
  s_mov_b32 exec_hi, 0x80000000
  v_mov_b32 v8, s35
  ds_write_b32 v8, v77 offset:0
  ds_write_b32 v8, v78 offset:4
  ds_write_b32 v8, v79 offset:8
  s_waitcnt lgkmcnt(0)
  v_mov_b32 v9, 1
  ds_write_b32 v8, v9 offset:12
  s_mov_b64 exec, -1
concat_heads__ssm_conv_s4d__mha_block__prompt_kernel_nopub:
  ds_bpermute_b32 v88, v6, v65
  ds_bpermute_b32 v89, v6, v66
  ds_bpermute_b32 v90, v6, v67
  ds_bpermute_b32 v91, v6, v69
  ds_bpermute_b32 v92, v6, v70
  ds_bpermute_b32 v93, v6, v71
  ds_bpermute_b32 v94, v6, v73
  ds_bpermute_b32 v95, v6, v74
  ds_bpermute_b32 v96, v6, v75
  ds_bpermute_b32 v97, v6, v77
  ds_bpermute_b32 v98, v6, v78
  ds_bpermute_b32 v99, v6, v79
  ds_bpermute_b32 v100, v7, v77
  ds_bpermute_b32 v101, v7, v78
  ds_bpermute_b32 v102, v7, v79
  v_add_f32 v17, v17, v32
  v_add_f32 v18, v18, v33
  v_add_f32 v19, v19, v34
  v_add_f32 v18, v18, v48
  v_add_f32 v19, v19, v49
  v_add_f32 v19, v19, v64
  v_add_f32 v21, v21, v36
  v_add_f32 v22, v22, v37
  v_add_f32 v23, v23, v38
  v_add_f32 v22, v22, v52
  v_add_f32 v23, v23, v53
  v_add_f32 v23, v23, v68
  v_add_f32 v25, v25, v40
  v_add_f32 v26, v26, v41
  v_add_f32 v27, v27, v42
  v_add_f32 v26, v26, v56
  v_add_f32 v27, v27, v57
  v_add_f32 v27, v27, v72
  v_add_f32 v29, v29, v44
  v_add_f32 v30, v30, v45
  v_add_f32 v31, v31, v46
  v_add_f32 v30, v30, v60
  v_add_f32 v31, v31, v61
  v_add_f32 v31, v31, v76
  s_waitcnt lgkmcnt(0)
  s_cmp_eq_u32 s28, 0
  s_cbranch_scc1 concat_heads__ssm_conv_s4d__mha_block__prompt_kernel_ext0
  v_mov_b32 v8, s35
  s_mov_b32 s38, 0
concat_heads__ssm_conv_s4d__mha_block__prompt_kernel_spin:
  ds_read_b128 v[104:107], v8
  s_waitcnt lgkmcnt(0)
  v_readfirstlane_b32 s39, v107
  s_add_u32 s38, s38, 1
  s_cmp_lg_u32 s39, 0
  s_cbranch_scc1 concat_heads__ssm_conv_s4d__mha_block__prompt_kernel_extok
  s_sleep 2
  s_cmp_lt_u32 s38, 0x100000
  s_cbranch_scc1 concat_heads__ssm_conv_s4d__mha_block__prompt_kernel_spin
  s_branch concat_heads__ssm_conv_s4d__mha_block__prompt_kernel_extok
concat_heads__ssm_conv_s4d__mha_block__prompt_kernel_ext0:
  v_mov_b32 v104, 0
  v_mov_b32 v105, 0
  v_mov_b32 v106, 0
concat_heads__ssm_conv_s4d__mha_block__prompt_kernel_extok:
  s_mov_b32 exec_lo, 1
  s_mov_b32 exec_hi, 0
  v_mov_b32 v100, v104
  v_mov_b32 v101, v105
  v_mov_b32 v102, v106
  s_mov_b32 exec_lo, 0
  s_mov_b32 exec_hi, -1
  v_add_f32 v16, v16, v88
  v_add_f32 v17, v17, v89
  v_add_f32 v18, v18, v90
  v_add_f32 v20, v20, v91
  v_add_f32 v21, v21, v92
  v_add_f32 v22, v22, v93
  v_add_f32 v24, v24, v94
  v_add_f32 v25, v25, v95
  v_add_f32 v26, v26, v96
  v_add_f32 v28, v28, v97
  v_add_f32 v29, v29, v98
  v_add_f32 v30, v30, v99
  s_mov_b32 exec_lo, -1
  s_mov_b32 exec_hi, 0
  v_add_f32 v20, v20, v88
  v_add_f32 v21, v21, v89
  v_add_f32 v22, v22, v90
  v_add_f32 v24, v24, v91
  v_add_f32 v25, v25, v92
  v_add_f32 v26, v26, v93
  v_add_f32 v28, v28, v94
  v_add_f32 v29, v29, v95
  v_add_f32 v30, v30, v96
  v_add_f32 v16, v16, v100
  v_add_f32 v17, v17, v101
  v_add_f32 v18, v18, v102
  s_mov_b64 exec, -1
  v_cvt_pk_bf16_f32 v56, v16, v17
  v_cvt_pk_bf16_f32 v57, v18, v19
  v_cvt_pk_bf16_f32 v58, v20, v21
  v_cvt_pk_bf16_f32 v59, v22, v23
  v_cvt_pk_bf16_f32 v60, v24, v25
  v_cvt_pk_bf16_f32 v61, v26, v27
  v_cvt_pk_bf16_f32 v62, v28, v29
  v_cvt_pk_bf16_f32 v63, v30, v31
  v_and_b32 v4, 31, v2
  v_lshlrev_b32 v4, 6, v4
  v_lshl_add_u32 v4, v5, 3, v4
  s_lshl_b32 s35, s27, 12
  s_lshl_b32 s36, s28, 11
  s_add_u32 s35, s35, s36
  s_add_u32 s35, s35, 12582912
  buffer_store_dwordx2 v[56:57], v4, s[12:15], s35 offen offset:0 sc0 sc1
  buffer_store_dwordx2 v[58:59], v4, s[12:15], s35 offen offset:16 sc0 sc1
  buffer_store_dwordx2 v[60:61], v4, s[12:15], s35 offen offset:32 sc0 sc1
  buffer_store_dwordx2 v[62:63], v4, s[12:15], s35 offen offset:48 sc0 sc1
  v_mov_b32 v9, 151848
  ds_read_b32 v8, v9
  s_load_dwordx2 s[4:5], s[0:1], 72
  s_waitcnt vmcnt(0) lgkmcnt(0)
  v_readfirstlane_b32 s69, v8
  s_mov_b32 s16, s4
  s_mov_b32 s17, s5
  s_mov_b32 s18, 524288
  s_mov_b32 s19, 0x20000
  v_mov_b32 v9, 151840
  v_mov_b32 v8, 1
  s_mov_b64 exec, 1
  ds_add_rtn_u32 v10, v9, v8
  s_waitcnt lgkmcnt(0)
  v_readfirstlane_b32 s40, v10
  s_cmp_eq_u32 s40, 3
  s_cbranch_scc0 concat_heads__ssm_conv_s4d__mha_block__prompt_kernel_nosig3
  s_lshl_b32 s47, s2, 7
  s_add_u32 s47, s47, 25362432
  v_mov_b32 v4, s47
  v_mov_b32 v5, s69
  global_store_dword v4, v5, s[8:9] sc0 sc1
concat_heads__ssm_conv_s4d__mha_block__prompt_kernel_nosig3:
  s_mov_b64 exec, -1
  s_sub_u32 s43, s24, 8
  v_and_b32 v6, 31, v2
  s_lshl_b32 s47, s26, 5
  v_add_u32 v6, s47, v6
  v_lshlrev_b32 v6, 7, v6
  v_add_u32 v6, 25362432, v6
  s_lshr_b32 s40, s30, 16
  s_and_b32 s41, s40, 7
  s_lshl_b32 s42, s26, 3
  s_add_u32 s41, s41, s42
  s_lshr_b32 s42, s40, 3
  v_lshrrev_b32 v4, 2, v2
  v_lshlrev_b32 v4, 10, v4
  v_and_b32 v5, 3, v2
  v_lshl_add_u32 v4, v5, 4, v4
  s_lshl_b32 s45, s42, 8
  s_lshl_b32 s46, s43, 6
  s_add_u32 s45, s45, s46
  s_add_u32 s47, s45, 0
  buffer_load_dwordx4 v[32:35], v4, s[16:19], s47 offen
  s_add_u32 s47, s45, 16384
  buffer_load_dwordx4 v[36:39], v4, s[16:19], s47 offen
  s_add_u32 s47, s45, 32768
  buffer_load_dwordx4 v[40:43], v4, s[16:19], s47 offen
  s_add_u32 s47, s45, 49152
  buffer_load_dwordx4 v[44:47], v4, s[16:19], s47 offen
  s_add_u32 s47, s45, 65536
  buffer_load_dwordx4 v[48:51], v4, s[16:19], s47 offen
  s_add_u32 s47, s45, 81920
  buffer_load_dwordx4 v[52:55], v4, s[16:19], s47 offen
  s_add_u32 s47, s45, 98304
  buffer_load_dwordx4 v[56:59], v4, s[16:19], s47 offen
  s_add_u32 s47, s45, 114688
  buffer_load_dwordx4 v[60:63], v4, s[16:19], s47 offen
  s_add_u32 s47, s45, 131072
  buffer_load_dwordx4 v[64:67], v4, s[16:19], s47 offen
  s_add_u32 s47, s45, 147456
  buffer_load_dwordx4 v[68:71], v4, s[16:19], s47 offen
  s_add_u32 s47, s45, 163840
  buffer_load_dwordx4 v[72:75], v4, s[16:19], s47 offen
  s_add_u32 s47, s45, 180224
  buffer_load_dwordx4 v[76:79], v4, s[16:19], s47 offen
  s_add_u32 s47, s45, 196608
  buffer_load_dwordx4 v[80:83], v4, s[16:19], s47 offen
  s_add_u32 s47, s45, 212992
  buffer_load_dwordx4 v[84:87], v4, s[16:19], s47 offen
  s_add_u32 s47, s45, 229376
  buffer_load_dwordx4 v[88:91], v4, s[16:19], s47 offen
  s_add_u32 s47, s45, 245760
  buffer_load_dwordx4 v[92:95], v4, s[16:19], s47 offen
  s_add_u32 s47, s45, 262144
  buffer_load_dwordx4 v[96:99], v4, s[16:19], s47 offen
  s_add_u32 s47, s45, 278528
  buffer_load_dwordx4 v[100:103], v4, s[16:19], s47 offen
  s_add_u32 s47, s45, 294912
  buffer_load_dwordx4 v[104:107], v4, s[16:19], s47 offen
  s_add_u32 s47, s45, 311296
  buffer_load_dwordx4 v[108:111], v4, s[16:19], s47 offen
  s_add_u32 s47, s45, 327680
  buffer_load_dwordx4 v[112:115], v4, s[16:19], s47 offen
  s_add_u32 s47, s45, 344064
  buffer_load_dwordx4 v[116:119], v4, s[16:19], s47 offen
  s_add_u32 s47, s45, 360448
  buffer_load_dwordx4 v[120:123], v4, s[16:19], s47 offen
  s_add_u32 s47, s45, 376832
  buffer_load_dwordx4 v[124:127], v4, s[16:19], s47 offen
  s_add_u32 s47, s45, 393216
  buffer_load_dwordx4 v[128:131], v4, s[16:19], s47 offen
  s_add_u32 s47, s45, 409600
  buffer_load_dwordx4 v[132:135], v4, s[16:19], s47 offen
  s_add_u32 s47, s45, 425984
  buffer_load_dwordx4 v[136:139], v4, s[16:19], s47 offen
  s_add_u32 s47, s45, 442368
  buffer_load_dwordx4 v[140:143], v4, s[16:19], s47 offen
  s_add_u32 s47, s45, 458752
  buffer_load_dwordx4 v[144:147], v4, s[16:19], s47 offen
  s_add_u32 s47, s45, 475136
  buffer_load_dwordx4 v[148:151], v4, s[16:19], s47 offen
  s_add_u32 s47, s45, 491520
  buffer_load_dwordx4 v[152:155], v4, s[16:19], s47 offen
  s_add_u32 s47, s45, 507904
  buffer_load_dwordx4 v[156:159], v4, s[16:19], s47 offen
  v_mov_b32 v9, 151840
  s_mov_b32 s62, 0
concat_heads__ssm_conv_s4d__mha_block__prompt_kernel_cw:
  ds_read_b32 v8, v9
  s_waitcnt lgkmcnt(0)
  v_readfirstlane_b32 s40, v8
  s_add_u32 s62, s62, 1
  s_cmp_ge_u32 s40, 4
  s_cbranch_scc1 concat_heads__ssm_conv_s4d__mha_block__prompt_kernel_cw_x
  s_sleep 8
  s_cmp_lt_u32 s62, 100000
  s_cbranch_scc1 concat_heads__ssm_conv_s4d__mha_block__prompt_kernel_cw
concat_heads__ssm_conv_s4d__mha_block__prompt_kernel_cw_x:
  s_lshl_b32 s48, s43, 12
  s_add_u32 s48, s48, 131072
  v_bfe_u32 v5, v2, 2, 2
  v_lshrrev_b32 v7, 5, v2
  v_lshl_add_u32 v5, v7, 3, v5
  v_lshlrev_b32 v5, 6, v5
  v_bfe_u32 v7, v2, 4, 1
  v_lshl_add_u32 v5, v7, 5, v5
  v_and_b32 v7, 3, v2
  v_lshl_add_u32 v5, v7, 3, v5
  v_add_u32 v5, s48, v5
  v_add_u32 v7, s48, v3
  s_waitcnt vmcnt(0)
  ds_write_b128 v7, v[32:35] offset:0
  ds_write_b128 v7, v[36:39] offset:1024
  ds_write_b128 v7, v[40:43] offset:2048
  ds_write_b128 v7, v[44:47] offset:3072
  s_waitcnt lgkmcnt(0)
  ds_read_b64_tr_b16 v[32:33], v5 offset:0
  ds_read_b64_tr_b16 v[34:35], v5 offset:256
  ds_read_b64_tr_b16 v[36:37], v5 offset:1024
  ds_read_b64_tr_b16 v[38:39], v5 offset:1280
  ds_read_b64_tr_b16 v[40:41], v5 offset:2048
  ds_read_b64_tr_b16 v[42:43], v5 offset:2304
  ds_read_b64_tr_b16 v[44:45], v5 offset:3072
  ds_read_b64_tr_b16 v[46:47], v5 offset:3328
  s_waitcnt lgkmcnt(0)
  ds_write_b128 v7, v[48:51] offset:0
  ds_write_b128 v7, v[52:55] offset:1024
  ds_write_b128 v7, v[56:59] offset:2048
  ds_write_b128 v7, v[60:63] offset:3072
  s_waitcnt lgkmcnt(0)
  ds_read_b64_tr_b16 v[48:49], v5 offset:0
  ds_read_b64_tr_b16 v[50:51], v5 offset:256
  ds_read_b64_tr_b16 v[52:53], v5 offset:1024
  ds_read_b64_tr_b16 v[54:55], v5 offset:1280
  ds_read_b64_tr_b16 v[56:57], v5 offset:2048
  ds_read_b64_tr_b16 v[58:59], v5 offset:2304
  ds_read_b64_tr_b16 v[60:61], v5 offset:3072
  ds_read_b64_tr_b16 v[62:63], v5 offset:3328
  s_waitcnt lgkmcnt(0)
  ds_write_b128 v7, v[64:67] offset:0
  ds_write_b128 v7, v[68:71] offset:1024
  ds_write_b128 v7, v[72:75] offset:2048
  ds_write_b128 v7, v[76:79] offset:3072
  s_waitcnt lgkmcnt(0)
  ds_read_b64_tr_b16 v[64:65], v5 offset:0
  ds_read_b64_tr_b16 v[66:67], v5 offset:256
  ds_read_b64_tr_b16 v[68:69], v5 offset:1024
  ds_read_b64_tr_b16 v[70:71], v5 offset:1280
  ds_read_b64_tr_b16 v[72:73], v5 offset:2048
  ds_read_b64_tr_b16 v[74:75], v5 offset:2304
  ds_read_b64_tr_b16 v[76:77], v5 offset:3072
  ds_read_b64_tr_b16 v[78:79], v5 offset:3328
  s_waitcnt lgkmcnt(0)
  ds_write_b128 v7, v[80:83] offset:0
  ds_write_b128 v7, v[84:87] offset:1024
  ds_write_b128 v7, v[88:91] offset:2048
  ds_write_b128 v7, v[92:95] offset:3072
  s_waitcnt lgkmcnt(0)
  ds_read_b64_tr_b16 v[80:81], v5 offset:0
  ds_read_b64_tr_b16 v[82:83], v5 offset:256
  ds_read_b64_tr_b16 v[84:85], v5 offset:1024
  ds_read_b64_tr_b16 v[86:87], v5 offset:1280
  ds_read_b64_tr_b16 v[88:89], v5 offset:2048
  ds_read_b64_tr_b16 v[90:91], v5 offset:2304
  ds_read_b64_tr_b16 v[92:93], v5 offset:3072
  ds_read_b64_tr_b16 v[94:95], v5 offset:3328
  s_waitcnt lgkmcnt(0)
  ds_write_b128 v7, v[96:99] offset:0
  ds_write_b128 v7, v[100:103] offset:1024
  ds_write_b128 v7, v[104:107] offset:2048
  ds_write_b128 v7, v[108:111] offset:3072
  s_waitcnt lgkmcnt(0)
  ds_read_b64_tr_b16 v[96:97], v5 offset:0
  ds_read_b64_tr_b16 v[98:99], v5 offset:256
  ds_read_b64_tr_b16 v[100:101], v5 offset:1024
  ds_read_b64_tr_b16 v[102:103], v5 offset:1280
  ds_read_b64_tr_b16 v[104:105], v5 offset:2048
  ds_read_b64_tr_b16 v[106:107], v5 offset:2304
  ds_read_b64_tr_b16 v[108:109], v5 offset:3072
  ds_read_b64_tr_b16 v[110:111], v5 offset:3328
  s_waitcnt lgkmcnt(0)
  ds_write_b128 v7, v[112:115] offset:0
  ds_write_b128 v7, v[116:119] offset:1024
  ds_write_b128 v7, v[120:123] offset:2048
  ds_write_b128 v7, v[124:127] offset:3072
  s_waitcnt lgkmcnt(0)
  ds_read_b64_tr_b16 v[112:113], v5 offset:0
  ds_read_b64_tr_b16 v[114:115], v5 offset:256
  ds_read_b64_tr_b16 v[116:117], v5 offset:1024
  ds_read_b64_tr_b16 v[118:119], v5 offset:1280
  ds_read_b64_tr_b16 v[120:121], v5 offset:2048
  ds_read_b64_tr_b16 v[122:123], v5 offset:2304
  ds_read_b64_tr_b16 v[124:125], v5 offset:3072
  ds_read_b64_tr_b16 v[126:127], v5 offset:3328
  s_waitcnt lgkmcnt(0)
  ds_write_b128 v7, v[128:131] offset:0
  ds_write_b128 v7, v[132:135] offset:1024
  ds_write_b128 v7, v[136:139] offset:2048
  ds_write_b128 v7, v[140:143] offset:3072
  s_waitcnt lgkmcnt(0)
  ds_read_b64_tr_b16 v[128:129], v5 offset:0
  ds_read_b64_tr_b16 v[130:131], v5 offset:256
  ds_read_b64_tr_b16 v[132:133], v5 offset:1024
  ds_read_b64_tr_b16 v[134:135], v5 offset:1280
  ds_read_b64_tr_b16 v[136:137], v5 offset:2048
  ds_read_b64_tr_b16 v[138:139], v5 offset:2304
  ds_read_b64_tr_b16 v[140:141], v5 offset:3072
  ds_read_b64_tr_b16 v[142:143], v5 offset:3328
  s_waitcnt lgkmcnt(0)
  ds_write_b128 v7, v[144:147] offset:0
  ds_write_b128 v7, v[148:151] offset:1024
  ds_write_b128 v7, v[152:155] offset:2048
  ds_write_b128 v7, v[156:159] offset:3072
  s_waitcnt lgkmcnt(0)
  ds_read_b64_tr_b16 v[144:145], v5 offset:0
  ds_read_b64_tr_b16 v[146:147], v5 offset:256
  ds_read_b64_tr_b16 v[148:149], v5 offset:1024
  ds_read_b64_tr_b16 v[150:151], v5 offset:1280
  ds_read_b64_tr_b16 v[152:153], v5 offset:2048
  ds_read_b64_tr_b16 v[154:155], v5 offset:2304
  ds_read_b64_tr_b16 v[156:157], v5 offset:3072
  ds_read_b64_tr_b16 v[158:159], v5 offset:3328
  s_waitcnt lgkmcnt(0)
  s_mov_b32 s62, 0
concat_heads__ssm_conv_s4d__mha_block__prompt_kernel_fp3:
  global_load_dword v7, v6, s[8:9] sc1
  s_waitcnt vmcnt(0)
  v_cmp_ne_u32 vcc, s69, v7
  s_add_u32 s62, s62, 1
  s_cmp_eq_u64 vcc, 0
  s_cbranch_scc1 concat_heads__ssm_conv_s4d__mha_block__prompt_kernel_fp3_x
  s_sleep 8
  s_cmp_lt_u32 s62, 100000
  s_cbranch_scc1 concat_heads__ssm_conv_s4d__mha_block__prompt_kernel_fp3
concat_heads__ssm_conv_s4d__mha_block__prompt_kernel_fp3_x:
  s_load_dwordx2 s[6:7], s[0:1], 80
  s_load_dwordx2 s[56:57], s[0:1], 0
  s_load_dwordx2 s[58:59], s[0:1], 48
  s_and_b32 s51, s2, 31
  v_lshrrev_b32 v4, 1, v2
  v_lshlrev_b32 v4, 12, v4
  v_and_b32 v5, 1, v2
  v_lshl_add_u32 v4, v5, 4, v4
  s_lshl_b32 s46, s26, 18
  s_lshl_b32 s47, s51, 7
  s_add_u32 s46, s46, s47
  s_lshl_b32 s47, s43, 5
  s_add_u32 s46, s46, s47
  s_add_u32 s46, s46, 12582912
  s_add_u32 m0, s48, 0
  s_add_u32 s47, s46, 0
  buffer_load_dwordx4 v4, s[12:15], s47 offen sc1 lds
  s_add_u32 m0, s48, 1024
  s_add_u32 s47, s46, 131072
  buffer_load_dwordx4 v4, s[12:15], s47 offen sc1 lds
  v_lshrrev_b32 v7, 4, v2
  v_and_b32 v6, 15, v2
  v_lshlrev_b32 v5, 10, v6
  v_lshl_add_u32 v5, v7, 4, v5
  s_lshl_b32 s44, s51, 16
  s_lshl_b32 s45, s43, 14
  s_add_u32 s44, s44, s45
  s_lshl_b32 s45, s26, 7
  s_add_u32 s44, s44, s45
  v_lshlrev_b32 v4, 4, v7
  v_lshlrev_b32 v166, 11, v6
  v_lshl_add_u32 v166, v7, 4, v166
  v_bfe_u32 v6, v2, 2, 2
  v_lshl_add_u32 v6, v7, 3, v6
  v_lshlrev_b32 v6, 5, v6
  v_and_b32 v7, 3, v2
  v_lshl_add_u32 v6, v7, 3, v6
  v_add_u32 v6, s48, v6
  s_waitcnt lgkmcnt(0)
  s_mov_b32 s20, s6
  s_mov_b32 s21, s7
  s_mov_b32 s22, 4194304
  s_mov_b32 s23, 0x20000
  s_mov_b32 s64, s56
  s_mov_b32 s65, s57
  s_mov_b32 s66, 2097152
  s_mov_b32 s67, 0x20000
  s_mov_b32 s56, s58
  s_mov_b32 s57, s59
  s_mov_b32 s58, 1024
  s_mov_b32 s59, 0x20000
  buffer_load_dwordx4 v[24:27], v5, s[64:67], s44 offen offset:0
  buffer_load_dwordx4 v[28:31], v5, s[64:67], s44 offen offset:64
  buffer_load_dwordx4 v[8:11], v4, s[56:59], s45 offen offset:0
  buffer_load_dwordx4 v[12:15], v4, s[56:59], s45 offen offset:64
  s_lshl_b32 s49, s51, 17
  s_lshl_b32 s47, s43, 15
  s_add_u32 s49, s49, s47
  s_lshl_b32 s47, s26, 7
  s_add_u32 s49, s49, s47
  s_waitcnt vmcnt(0)
  ds_read_b64_tr_b16 v[16:17], v6 offset:0
  ds_read_b64_tr_b16 v[18:19], v6 offset:128
  ds_read_b64_tr_b16 v[20:21], v6 offset:1024
  ds_read_b64_tr_b16 v[22:23], v6 offset:1152
  s_waitcnt lgkmcnt(0)
  s_setprio 0
  s_barrier
  s_barrier
  v_and_b32 v164, 7, v2
  v_lshlrev_b32 v164, 2, v164
  v_add_u32 v164, 151872, v164
  ds_read_b32 v165, v164
  s_waitcnt lgkmcnt(0)
  v_cmp_ne_u32 vcc, 0, v165
  s_cmp_lg_u64 vcc, 0
  s_cbranch_scc0 concat_heads__ssm_conv_s4d__mha_block__prompt_kernel_p3ld
  s_barrier
  s_barrier
  s_sub_u32 s51, s24, 8
  s_lshl_b32 s51, s51, 14
  s_add_u32 s50, s30, s51
  s_add_u32 m0, s51, 0
  s_add_u32 s52, s50, 2097152
  buffer_load_dwordx4 v3, s[12:15], s52 offen sc1 lds
  s_add_u32 m0, s51, 65536
  s_add_u32 s52, s50, 4194304
  buffer_load_dwordx4 v3, s[12:15], s52 offen sc1 lds
  s_add_u32 m0, s51, 1024
  s_add_u32 s52, s50, 2098176
  buffer_load_dwordx4 v3, s[12:15], s52 offen sc1 lds
  s_add_u32 m0, s51, 66560
  s_add_u32 s52, s50, 4195328
  buffer_load_dwordx4 v3, s[12:15], s52 offen sc1 lds
  s_add_u32 m0, s51, 2048
  s_add_u32 s52, s50, 2099200
  buffer_load_dwordx4 v3, s[12:15], s52 offen sc1 lds
  s_add_u32 m0, s51, 67584
  s_add_u32 s52, s50, 4196352
  buffer_load_dwordx4 v3, s[12:15], s52 offen sc1 lds
  s_add_u32 m0, s51, 3072
  s_add_u32 s52, s50, 2100224
  buffer_load_dwordx4 v3, s[12:15], s52 offen sc1 lds
  s_add_u32 m0, s51, 68608
  s_add_u32 s52, s50, 4197376
  buffer_load_dwordx4 v3, s[12:15], s52 offen sc1 lds
  s_add_u32 m0, s51, 4096
  s_add_u32 s52, s50, 2101248
  buffer_load_dwordx4 v3, s[12:15], s52 offen sc1 lds
  s_add_u32 m0, s51, 69632
  s_add_u32 s52, s50, 4198400
  buffer_load_dwordx4 v3, s[12:15], s52 offen sc1 lds
  s_add_u32 m0, s51, 5120
  s_add_u32 s52, s50, 2102272
  buffer_load_dwordx4 v3, s[12:15], s52 offen sc1 lds
  s_add_u32 m0, s51, 70656
  s_add_u32 s52, s50, 4199424
  buffer_load_dwordx4 v3, s[12:15], s52 offen sc1 lds
  s_add_u32 m0, s51, 6144
  s_add_u32 s52, s50, 2103296
  buffer_load_dwordx4 v3, s[12:15], s52 offen sc1 lds
  s_add_u32 m0, s51, 71680
  s_add_u32 s52, s50, 4200448
  buffer_load_dwordx4 v3, s[12:15], s52 offen sc1 lds
  s_add_u32 m0, s51, 7168
  s_add_u32 s52, s50, 2104320
  buffer_load_dwordx4 v3, s[12:15], s52 offen sc1 lds
  s_add_u32 m0, s51, 72704
  s_add_u32 s52, s50, 4201472
  buffer_load_dwordx4 v3, s[12:15], s52 offen sc1 lds
  s_add_u32 m0, s51, 8192
  s_add_u32 s52, s50, 2105344
  buffer_load_dwordx4 v3, s[12:15], s52 offen sc1 lds
  s_add_u32 m0, s51, 73728
  s_add_u32 s52, s50, 4202496
  buffer_load_dwordx4 v3, s[12:15], s52 offen sc1 lds
  s_add_u32 m0, s51, 9216
  s_add_u32 s52, s50, 2106368
  buffer_load_dwordx4 v3, s[12:15], s52 offen sc1 lds
  s_add_u32 m0, s51, 74752
  s_add_u32 s52, s50, 4203520
  buffer_load_dwordx4 v3, s[12:15], s52 offen sc1 lds
  s_add_u32 m0, s51, 10240
  s_add_u32 s52, s50, 2107392
  buffer_load_dwordx4 v3, s[12:15], s52 offen sc1 lds
  s_add_u32 m0, s51, 75776
  s_add_u32 s52, s50, 4204544
  buffer_load_dwordx4 v3, s[12:15], s52 offen sc1 lds
  s_add_u32 m0, s51, 11264
  s_add_u32 s52, s50, 2108416
  buffer_load_dwordx4 v3, s[12:15], s52 offen sc1 lds
  s_add_u32 m0, s51, 76800
  s_add_u32 s52, s50, 4205568
  buffer_load_dwordx4 v3, s[12:15], s52 offen sc1 lds
  s_add_u32 m0, s51, 12288
  s_add_u32 s52, s50, 2109440
  buffer_load_dwordx4 v3, s[12:15], s52 offen sc1 lds
  s_add_u32 m0, s51, 77824
  s_add_u32 s52, s50, 4206592
  buffer_load_dwordx4 v3, s[12:15], s52 offen sc1 lds
  s_add_u32 m0, s51, 13312
  s_add_u32 s52, s50, 2110464
  buffer_load_dwordx4 v3, s[12:15], s52 offen sc1 lds
  s_add_u32 m0, s51, 78848
  s_add_u32 s52, s50, 4207616
  buffer_load_dwordx4 v3, s[12:15], s52 offen sc1 lds
  s_add_u32 m0, s51, 14336
  s_add_u32 s52, s50, 2111488
  buffer_load_dwordx4 v3, s[12:15], s52 offen sc1 lds
  s_add_u32 m0, s51, 79872
  s_add_u32 s52, s50, 4208640
  buffer_load_dwordx4 v3, s[12:15], s52 offen sc1 lds
  s_add_u32 m0, s51, 15360
  s_add_u32 s52, s50, 2112512
  buffer_load_dwordx4 v3, s[12:15], s52 offen sc1 lds
  s_add_u32 m0, s51, 80896
  s_add_u32 s52, s50, 4209664
  buffer_load_dwordx4 v3, s[12:15], s52 offen sc1 lds
  s_waitcnt vmcnt(0)
  s_barrier
  s_barrier
  s_barrier
  s_barrier
  s_barrier
  s_barrier
concat_heads__ssm_conv_s4d__mha_block__prompt_kernel_p3ld:
concat_heads__ssm_conv_s4d__mha_block__prompt_kernel_e:
  s_cmp_ge_u32 s24, 8
  s_cbranch_scc1 concat_heads__ssm_conv_s4d__mha_block__prompt_kernel_p3c
  s_lshr_b32 s40, s30, 16
  s_and_b32 s41, s40, 7
  s_lshl_b32 s42, s26, 3
  s_add_u32 s41, s41, s42
  s_lshl_b32 s54, s24, 18
  s_lshl_b32 s55, s41, 10
  s_add_u32 s54, s54, s55
  s_add_u32 s54, s54, 6291456
  s_lshl_b32 s53, s24, 12
  s_add_u32 s53, s53, 73728
  v_add_u32 v12, s53, v3
  v_and_b32 v9, 3, v2
  v_lshlrev_b32 v9, 16, v9
  v_add_u32 v9, 1020, v9
  s_mov_b32 s62, 0
  buffer_load_dword v60, v9, s[12:15], s54 offen sc1
  buffer_load_dword v61, v9, s[12:15], s54 offen sc1
concat_heads__ssm_conv_s4d__mha_block__prompt_kernel_pr:
  buffer_load_dword v62, v9, s[12:15], s54 offen sc1
  s_waitcnt vmcnt(2)
  v_cmp_eq_u32 vcc, -1, v60
  s_cmp_eq_u64 vcc, 0
  s_cbranch_scc1 concat_heads__ssm_conv_s4d__mha_block__prompt_kernel_pr_x
  buffer_load_dword v60, v9, s[12:15], s54 offen sc1
  s_waitcnt vmcnt(2)
  v_cmp_eq_u32 vcc, -1, v61
  s_cmp_eq_u64 vcc, 0
  s_cbranch_scc1 concat_heads__ssm_conv_s4d__mha_block__prompt_kernel_pr_x
  buffer_load_dword v61, v9, s[12:15], s54 offen sc1
  s_waitcnt vmcnt(2)
  v_cmp_eq_u32 vcc, -1, v62
  s_cmp_eq_u64 vcc, 0
  s_cbranch_scc1 concat_heads__ssm_conv_s4d__mha_block__prompt_kernel_pr_x
  s_add_u32 s62, s62, 1
  s_cmp_lt_u32 s62, 20000
  s_cbranch_scc1 concat_heads__ssm_conv_s4d__mha_block__prompt_kernel_pr
concat_heads__ssm_conv_s4d__mha_block__prompt_kernel_pr_x:
  s_mov_b32 s62, 0
  s_mov_b32 s56, 15
concat_heads__ssm_conv_s4d__mha_block__prompt_kernel_op:
  s_bitcmp1_b32 s56, 0
  s_cbranch_scc0 concat_heads__ssm_conv_s4d__mha_block__prompt_kernel_opl0
  s_add_u32 s47, s54, 0
  buffer_load_dwordx4 v[32:35], v3, s[12:15], s47 offen sc1
concat_heads__ssm_conv_s4d__mha_block__prompt_kernel_opl0:
  s_bitcmp1_b32 s56, 1
  s_cbranch_scc0 concat_heads__ssm_conv_s4d__mha_block__prompt_kernel_opl1
  s_add_u32 s47, s54, 65536
  buffer_load_dwordx4 v[36:39], v3, s[12:15], s47 offen sc1
concat_heads__ssm_conv_s4d__mha_block__prompt_kernel_opl1:
  s_bitcmp1_b32 s56, 2
  s_cbranch_scc0 concat_heads__ssm_conv_s4d__mha_block__prompt_kernel_opl2
  s_add_u32 s47, s54, 131072
  buffer_load_dwordx4 v[40:43], v3, s[12:15], s47 offen sc1
concat_heads__ssm_conv_s4d__mha_block__prompt_kernel_opl2:
  s_bitcmp1_b32 s56, 3
  s_cbranch_scc0 concat_heads__ssm_conv_s4d__mha_block__prompt_kernel_opl3
  s_add_u32 s47, s54, 196608
  buffer_load_dwordx4 v[44:47], v3, s[12:15], s47 offen sc1
concat_heads__ssm_conv_s4d__mha_block__prompt_kernel_opl3:
  s_waitcnt vmcnt(0)
  s_bitcmp1_b32 s56, 0
  s_cbranch_scc0 concat_heads__ssm_conv_s4d__mha_block__prompt_kernel_opc0
  v_cmp_eq_u32 vcc, -1, v32
  s_mov_b64 s[44:45], vcc
  v_cmp_eq_u32 vcc, -1, v35
  s_or_b64 s[44:45], s[44:45], vcc
  s_cmp_eq_u64 s[44:45], 0
  s_cbranch_scc0 concat_heads__ssm_conv_s4d__mha_block__prompt_kernel_opc0
  ds_write_b128 v12, v[32:35] offset:0
  s_bitset0_b32 s56, 0
concat_heads__ssm_conv_s4d__mha_block__prompt_kernel_opc0:
  s_bitcmp1_b32 s56, 1
  s_cbranch_scc0 concat_heads__ssm_conv_s4d__mha_block__prompt_kernel_opc1
  v_cmp_eq_u32 vcc, -1, v36
  s_mov_b64 s[44:45], vcc
  v_cmp_eq_u32 vcc, -1, v39
  s_or_b64 s[44:45], s[44:45], vcc
  s_cmp_eq_u64 s[44:45], 0
  s_cbranch_scc0 concat_heads__ssm_conv_s4d__mha_block__prompt_kernel_opc1
  ds_write_b128 v12, v[36:39] offset:1024
  s_bitset0_b32 s56, 1
concat_heads__ssm_conv_s4d__mha_block__prompt_kernel_opc1:
  s_bitcmp1_b32 s56, 2
  s_cbranch_scc0 concat_heads__ssm_conv_s4d__mha_block__prompt_kernel_opc2
  v_cmp_eq_u32 vcc, -1, v40
  s_mov_b64 s[44:45], vcc
  v_cmp_eq_u32 vcc, -1, v43
  s_or_b64 s[44:45], s[44:45], vcc
  s_cmp_eq_u64 s[44:45], 0
  s_cbranch_scc0 concat_heads__ssm_conv_s4d__mha_block__prompt_kernel_opc2
  ds_write_b128 v12, v[40:43] offset:2048
  s_bitset0_b32 s56, 2
concat_heads__ssm_conv_s4d__mha_block__prompt_kernel_opc2:
  s_bitcmp1_b32 s56, 3
  s_cbranch_scc0 concat_heads__ssm_conv_s4d__mha_block__prompt_kernel_opc3
  v_cmp_eq_u32 vcc, -1, v44
  s_mov_b64 s[44:45], vcc
  v_cmp_eq_u32 vcc, -1, v47
  s_or_b64 s[44:45], s[44:45], vcc
  s_cmp_eq_u64 s[44:45], 0
  s_cbranch_scc0 concat_heads__ssm_conv_s4d__mha_block__prompt_kernel_opc3
  ds_write_b128 v12, v[44:47] offset:3072
  s_bitset0_b32 s56, 3
concat_heads__ssm_conv_s4d__mha_block__prompt_kernel_opc3:
  s_add_u32 s62, s62, 1
  s_cmp_eq_u32 s56, 0
  s_cbranch_scc1 concat_heads__ssm_conv_s4d__mha_block__prompt_kernel_op_x
  s_cmp_lt_u32 s62, 20000
  s_cbranch_scc1 concat_heads__ssm_conv_s4d__mha_block__prompt_kernel_op
concat_heads__ssm_conv_s4d__mha_block__prompt_kernel_op_x:
  s_waitcnt lgkmcnt(0)
  s_lshr_b32 s47, s24, 1
  s_lshl_b32 s47, s47, 2
  s_add_u32 s47, s47, 151936
  v_mov_b32 v9, s47
  v_mov_b32 v8, 1
  s_mov_b64 exec, 1
  ds_add_u32 v9, v8
  s_mov_b64 exec, -1
  s_branch concat_heads__ssm_conv_s4d__mha_block__prompt_kernel_fin
concat_heads__ssm_conv_s4d__mha_block__prompt_kernel_p3c:
  v_lshlrev_b32 v160, 16, v24
  v_lshlrev_b32 v161, 16, v8
  v_and_b32 v162, 0xffff0000, v24
  v_and_b32 v163, 0xffff0000, v8
  v_mul_f32 v160, v160, v161
  v_mul_f32 v162, v162, v163
  v_cvt_pk_bf16_f32 v160, v160, v162
  v_lshlrev_b32 v161, 16, v16
  v_and_b32 v163, 0xffff0000, v16
  v_lshlrev_b32 v162, 16, v160
  v_and_b32 v160, 0xffff0000, v160
  v_add_f32 v161, v161, v162
  v_add_f32 v163, v163, v160
  v_cvt_pk_bf16_f32 v24, v161, v163
  v_lshlrev_b32 v160, 16, v25
  v_lshlrev_b32 v161, 16, v9
  v_and_b32 v162, 0xffff0000, v25
  v_and_b32 v163, 0xffff0000, v9
  v_mul_f32 v160, v160, v161
  v_mul_f32 v162, v162, v163
  v_cvt_pk_bf16_f32 v160, v160, v162
  v_lshlrev_b32 v161, 16, v17
  v_and_b32 v163, 0xffff0000, v17
  v_lshlrev_b32 v162, 16, v160
  v_and_b32 v160, 0xffff0000, v160
  v_add_f32 v161, v161, v162
  v_add_f32 v163, v163, v160
  v_cvt_pk_bf16_f32 v25, v161, v163
  v_lshlrev_b32 v160, 16, v26
  v_lshlrev_b32 v161, 16, v10
  v_and_b32 v162, 0xffff0000, v26
  v_and_b32 v163, 0xffff0000, v10
  v_mul_f32 v160, v160, v161
  v_mul_f32 v162, v162, v163
  v_cvt_pk_bf16_f32 v160, v160, v162
  v_lshlrev_b32 v161, 16, v18
  v_and_b32 v163, 0xffff0000, v18
  v_lshlrev_b32 v162, 16, v160
  v_and_b32 v160, 0xffff0000, v160
  v_add_f32 v161, v161, v162
  v_add_f32 v163, v163, v160
  v_cvt_pk_bf16_f32 v26, v161, v163
  v_lshlrev_b32 v160, 16, v27
  v_lshlrev_b32 v161, 16, v11
  v_and_b32 v162, 0xffff0000, v27
  v_and_b32 v163, 0xffff0000, v11
  v_mul_f32 v160, v160, v161
  v_mul_f32 v162, v162, v163
  v_cvt_pk_bf16_f32 v160, v160, v162
  v_lshlrev_b32 v161, 16, v19
  v_and_b32 v163, 0xffff0000, v19
  v_lshlrev_b32 v162, 16, v160
  v_and_b32 v160, 0xffff0000, v160
  v_add_f32 v161, v161, v162
  v_add_f32 v163, v163, v160
  v_cvt_pk_bf16_f32 v27, v161, v163
  v_lshlrev_b32 v160, 16, v28
  v_lshlrev_b32 v161, 16, v12
  v_and_b32 v162, 0xffff0000, v28
  v_and_b32 v163, 0xffff0000, v12
  v_mul_f32 v160, v160, v161
  v_mul_f32 v162, v162, v163
  v_cvt_pk_bf16_f32 v160, v160, v162
  v_lshlrev_b32 v161, 16, v20
  v_and_b32 v163, 0xffff0000, v20
  v_lshlrev_b32 v162, 16, v160
  v_and_b32 v160, 0xffff0000, v160
  v_add_f32 v161, v161, v162
  v_add_f32 v163, v163, v160
  v_cvt_pk_bf16_f32 v28, v161, v163
  v_lshlrev_b32 v160, 16, v29
  v_lshlrev_b32 v161, 16, v13
  v_and_b32 v162, 0xffff0000, v29
  v_and_b32 v163, 0xffff0000, v13
  v_mul_f32 v160, v160, v161
  v_mul_f32 v162, v162, v163
  v_cvt_pk_bf16_f32 v160, v160, v162
  v_lshlrev_b32 v161, 16, v21
  v_and_b32 v163, 0xffff0000, v21
  v_lshlrev_b32 v162, 16, v160
  v_and_b32 v160, 0xffff0000, v160
  v_add_f32 v161, v161, v162
  v_add_f32 v163, v163, v160
  v_cvt_pk_bf16_f32 v29, v161, v163
  v_lshlrev_b32 v160, 16, v30
  v_lshlrev_b32 v161, 16, v14
  v_and_b32 v162, 0xffff0000, v30
  v_and_b32 v163, 0xffff0000, v14
  v_mul_f32 v160, v160, v161
  v_mul_f32 v162, v162, v163
  v_cvt_pk_bf16_f32 v160, v160, v162
  v_lshlrev_b32 v161, 16, v22
  v_and_b32 v163, 0xffff0000, v22
  v_lshlrev_b32 v162, 16, v160
  v_and_b32 v160, 0xffff0000, v160
  v_add_f32 v161, v161, v162
  v_add_f32 v163, v163, v160
  v_cvt_pk_bf16_f32 v30, v161, v163
  v_lshlrev_b32 v160, 16, v31
  v_lshlrev_b32 v161, 16, v15
  v_and_b32 v162, 0xffff0000, v31
  v_and_b32 v163, 0xffff0000, v15
  v_mul_f32 v160, v160, v161
  v_mul_f32 v162, v162, v163
  v_cvt_pk_bf16_f32 v160, v160, v162
  v_lshlrev_b32 v161, 16, v23
  v_and_b32 v163, 0xffff0000, v23
  v_lshlrev_b32 v162, 16, v160
  v_and_b32 v160, 0xffff0000, v160
  v_add_f32 v161, v161, v162
  v_add_f32 v163, v163, v160
  v_cvt_pk_bf16_f32 v31, v161, v163
  buffer_store_dwordx4 v[24:27], v166, s[20:23], s49 offen offset:0
  buffer_store_dwordx4 v[28:31], v166, s[20:23], s49 offen offset:64
  v_mov_b32 v16, 0
  v_mov_b32 v17, 0
  v_mov_b32 v18, 0
  v_mov_b32 v19, 0
  v_mov_b32 v20, 0
  v_mov_b32 v21, 0
  v_mov_b32 v22, 0
  v_mov_b32 v23, 0
  v_mov_b32 v24, 0
  v_mov_b32 v25, 0
  v_mov_b32 v26, 0
  v_mov_b32 v27, 0
  v_mov_b32 v28, 0
  v_mov_b32 v29, 0
  v_mov_b32 v30, 0
  v_mov_b32 v31, 0
  v_and_b32 v4, 31, v2
  v_lshlrev_b32 v4, 11, v4
  v_lshrrev_b32 v5, 5, v2
  v_lshl_add_u32 v4, v5, 3, v4
  s_lshl_b32 s44, s41, 16
  s_lshl_b32 s45, s42, 8
  s_add_u32 s44, s44, s45
  s_lshl_b32 s45, s43, 6
  s_add_u32 s44, s44, s45
  s_add_u32 s44, s44, 1024
  v_add_u32 v12, 73728, v3
  v_mov_b32 v9, 151936
  s_mov_b32 s62, 0
concat_heads__ssm_conv_s4d__mha_block__prompt_kernel_oc0:
  ds_read_b32 v8, v9
  s_waitcnt lgkmcnt(0)
  v_readfirstlane_b32 s63, v8
  s_add_u32 s62, s62, 1
  s_cmp_ge_u32 s63, 2
  s_cbranch_scc1 concat_heads__ssm_conv_s4d__mha_block__prompt_kernel_oc0_x
  s_sleep 1
  s_cmp_lt_u32 s62, 0x400000
  s_cbranch_scc1 concat_heads__ssm_conv_s4d__mha_block__prompt_kernel_oc0
concat_heads__ssm_conv_s4d__mha_block__prompt_kernel_oc0_x:
  ds_read_b128 v[160:163], v12 offset:0
  ds_read_b128 v[164:167], v12 offset:1024
  s_waitcnt lgkmcnt(1)
  v_mfma_f32_32x32x16_bf16 v[16:31], v[32:35], v[160:163], v[16:31]
  ds_read_b128 v[160:163], v12 offset:2048
  s_waitcnt lgkmcnt(1)
  v_mfma_f32_32x32x16_bf16 v[16:31], v[36:39], v[164:167], v[16:31]
  ds_read_b128 v[164:167], v12 offset:3072
  s_waitcnt lgkmcnt(1)
  v_mfma_f32_32x32x16_bf16 v[16:31], v[40:43], v[160:163], v[16:31]
  ds_read_b128 v[160:163], v12 offset:4096
  s_waitcnt lgkmcnt(1)
  v_mfma_f32_32x32x16_bf16 v[16:31], v[44:47], v[164:167], v[16:31]
  ds_read_b128 v[164:167], v12 offset:5120
  s_waitcnt lgkmcnt(1)
  v_mfma_f32_32x32x16_bf16 v[16:31], v[48:51], v[160:163], v[16:31]
  ds_read_b128 v[160:163], v12 offset:6144
  s_waitcnt lgkmcnt(1)
  v_mfma_f32_32x32x16_bf16 v[16:31], v[52:55], v[164:167], v[16:31]
  ds_read_b128 v[164:167], v12 offset:7168
  s_waitcnt lgkmcnt(1)
  v_mfma_f32_32x32x16_bf16 v[16:31], v[56:59], v[160:163], v[16:31]
  s_waitcnt lgkmcnt(0)
  v_mfma_f32_32x32x16_bf16 v[16:31], v[60:63], v[164:167], v[16:31]
  v_mov_b32 v9, 151940
  s_mov_b32 s62, 0
concat_heads__ssm_conv_s4d__mha_block__prompt_kernel_oc1:
  ds_read_b32 v8, v9
  s_waitcnt lgkmcnt(0)
  v_readfirstlane_b32 s63, v8
  s_add_u32 s62, s62, 1
  s_cmp_ge_u32 s63, 2
  s_cbranch_scc1 concat_heads__ssm_conv_s4d__mha_block__prompt_kernel_oc1_x
  s_sleep 1
  s_cmp_lt_u32 s62, 0x400000
  s_cbranch_scc1 concat_heads__ssm_conv_s4d__mha_block__prompt_kernel_oc1
concat_heads__ssm_conv_s4d__mha_block__prompt_kernel_oc1_x:
  ds_read_b128 v[160:163], v12 offset:8192
  ds_read_b128 v[164:167], v12 offset:9216
  s_waitcnt lgkmcnt(1)
  v_mfma_f32_32x32x16_bf16 v[16:31], v[64:67], v[160:163], v[16:31]
  ds_read_b128 v[160:163], v12 offset:10240
  s_waitcnt lgkmcnt(1)
  v_mfma_f32_32x32x16_bf16 v[16:31], v[68:71], v[164:167], v[16:31]
  ds_read_b128 v[164:167], v12 offset:11264
  s_waitcnt lgkmcnt(1)
  v_mfma_f32_32x32x16_bf16 v[16:31], v[72:75], v[160:163], v[16:31]
  ds_read_b128 v[160:163], v12 offset:12288
  s_waitcnt lgkmcnt(1)
  v_mfma_f32_32x32x16_bf16 v[16:31], v[76:79], v[164:167], v[16:31]
  ds_read_b128 v[164:167], v12 offset:13312
  s_waitcnt lgkmcnt(1)
  v_mfma_f32_32x32x16_bf16 v[16:31], v[80:83], v[160:163], v[16:31]
  ds_read_b128 v[160:163], v12 offset:14336
  s_waitcnt lgkmcnt(1)
  v_mfma_f32_32x32x16_bf16 v[16:31], v[84:87], v[164:167], v[16:31]
  ds_read_b128 v[164:167], v12 offset:15360
  s_waitcnt lgkmcnt(1)
  v_mfma_f32_32x32x16_bf16 v[16:31], v[88:91], v[160:163], v[16:31]
  s_waitcnt lgkmcnt(0)
  v_mfma_f32_32x32x16_bf16 v[16:31], v[92:95], v[164:167], v[16:31]
  v_mov_b32 v9, 151944
  s_mov_b32 s62, 0
concat_heads__ssm_conv_s4d__mha_block__prompt_kernel_oc2:
  ds_read_b32 v8, v9
  s_waitcnt lgkmcnt(0)
  v_readfirstlane_b32 s63, v8
  s_add_u32 s62, s62, 1
  s_cmp_ge_u32 s63, 2
  s_cbranch_scc1 concat_heads__ssm_conv_s4d__mha_block__prompt_kernel_oc2_x
  s_sleep 1
  s_cmp_lt_u32 s62, 0x400000
  s_cbranch_scc1 concat_heads__ssm_conv_s4d__mha_block__prompt_kernel_oc2
concat_heads__ssm_conv_s4d__mha_block__prompt_kernel_oc2_x:
  ds_read_b128 v[160:163], v12 offset:16384
  ds_read_b128 v[164:167], v12 offset:17408
  s_waitcnt lgkmcnt(1)
  v_mfma_f32_32x32x16_bf16 v[16:31], v[96:99], v[160:163], v[16:31]
  ds_read_b128 v[160:163], v12 offset:18432
  s_waitcnt lgkmcnt(1)
  v_mfma_f32_32x32x16_bf16 v[16:31], v[100:103], v[164:167], v[16:31]
  ds_read_b128 v[164:167], v12 offset:19456
  s_waitcnt lgkmcnt(1)
  v_mfma_f32_32x32x16_bf16 v[16:31], v[104:107], v[160:163], v[16:31]
  ds_read_b128 v[160:163], v12 offset:20480
  s_waitcnt lgkmcnt(1)
  v_mfma_f32_32x32x16_bf16 v[16:31], v[108:111], v[164:167], v[16:31]
  ds_read_b128 v[164:167], v12 offset:21504
  s_waitcnt lgkmcnt(1)
  v_mfma_f32_32x32x16_bf16 v[16:31], v[112:115], v[160:163], v[16:31]
  ds_read_b128 v[160:163], v12 offset:22528
  s_waitcnt lgkmcnt(1)
  v_mfma_f32_32x32x16_bf16 v[16:31], v[116:119], v[164:167], v[16:31]
  ds_read_b128 v[164:167], v12 offset:23552
  s_waitcnt lgkmcnt(1)
  v_mfma_f32_32x32x16_bf16 v[16:31], v[120:123], v[160:163], v[16:31]
  s_waitcnt lgkmcnt(0)
  v_mfma_f32_32x32x16_bf16 v[16:31], v[124:127], v[164:167], v[16:31]
  v_mov_b32 v9, 151948
  s_mov_b32 s62, 0
concat_heads__ssm_conv_s4d__mha_block__prompt_kernel_oc3:
  ds_read_b32 v8, v9
  s_waitcnt lgkmcnt(0)
  v_readfirstlane_b32 s63, v8
  s_add_u32 s62, s62, 1
  s_cmp_ge_u32 s63, 2
  s_cbranch_scc1 concat_heads__ssm_conv_s4d__mha_block__prompt_kernel_oc3_x
  s_sleep 1
  s_cmp_lt_u32 s62, 0x400000
  s_cbranch_scc1 concat_heads__ssm_conv_s4d__mha_block__prompt_kernel_oc3
concat_heads__ssm_conv_s4d__mha_block__prompt_kernel_oc3_x:
  ds_read_b128 v[160:163], v12 offset:24576
  ds_read_b128 v[164:167], v12 offset:25600
  s_waitcnt lgkmcnt(1)
  v_mfma_f32_32x32x16_bf16 v[16:31], v[128:131], v[160:163], v[16:31]
  ds_read_b128 v[160:163], v12 offset:26624
  s_waitcnt lgkmcnt(1)
  v_mfma_f32_32x32x16_bf16 v[16:31], v[132:135], v[164:167], v[16:31]
  ds_read_b128 v[164:167], v12 offset:27648
  s_waitcnt lgkmcnt(1)
  v_mfma_f32_32x32x16_bf16 v[16:31], v[136:139], v[160:163], v[16:31]
  ds_read_b128 v[160:163], v12 offset:28672
  s_waitcnt lgkmcnt(1)
  v_mfma_f32_32x32x16_bf16 v[16:31], v[140:143], v[164:167], v[16:31]
  ds_read_b128 v[164:167], v12 offset:29696
  s_waitcnt lgkmcnt(1)
  v_mfma_f32_32x32x16_bf16 v[16:31], v[144:147], v[160:163], v[16:31]
  ds_read_b128 v[160:163], v12 offset:30720
  s_waitcnt lgkmcnt(1)
  v_mfma_f32_32x32x16_bf16 v[16:31], v[148:151], v[164:167], v[16:31]
  ds_read_b128 v[164:167], v12 offset:31744
  s_waitcnt lgkmcnt(1)
  v_mfma_f32_32x32x16_bf16 v[16:31], v[152:155], v[160:163], v[16:31]
  s_waitcnt lgkmcnt(0)
  v_mfma_f32_32x32x16_bf16 v[16:31], v[156:159], v[164:167], v[16:31]
  s_nop 7
  s_nop 3
  v_cvt_pk_bf16_f32 v32, v16, v17
  v_cvt_pk_bf16_f32 v33, v18, v19
  v_cvt_pk_bf16_f32 v34, v20, v21
  v_cvt_pk_bf16_f32 v35, v22, v23
  v_cvt_pk_bf16_f32 v36, v24, v25
  v_cvt_pk_bf16_f32 v37, v26, v27
  v_cvt_pk_bf16_f32 v38, v28, v29
  v_cvt_pk_bf16_f32 v39, v30, v31
  buffer_store_dwordx2 v[32:33], v4, s[20:23], s44 offen offset:0
  buffer_store_dwordx2 v[34:35], v4, s[20:23], s44 offen offset:16
  buffer_store_dwordx2 v[36:37], v4, s[20:23], s44 offen offset:32
  buffer_store_dwordx2 v[38:39], v4, s[20:23], s44 offen offset:48
concat_heads__ssm_conv_s4d__mha_block__prompt_kernel_fin:
concat_heads__ssm_conv_s4d__mha_block__prompt_kernel_end:
  s_endpgm
.section .rodata,"a"
.p2align 6
.amdhsa_kernel concat_heads__ssm_conv_s4d__mha_block__prompt_kernel
  .amdhsa_next_free_vgpr 168
  .amdhsa_next_free_sgpr 100
  .amdhsa_accum_offset 168
  .amdhsa_group_segment_fixed_size 0
  .amdhsa_kernarg_size 104
  .amdhsa_user_sgpr_count 2
  .amdhsa_user_sgpr_kernarg_segment_ptr 1
  .amdhsa_system_sgpr_workgroup_id_x 1
.end_amdhsa_kernel
```
